```python
import torch

def _softmax(x, axis=-1):
    return torch.softmax(x, dim=axis)
def _gelu(x):
    return torch.nn.functional.gelu(x, approximate="tanh")
def _silu(x):
    return torch.nn.functional.silu(x)
def _sigmoid(x):
    return torch.sigmoid(x)
def _layernorm(x, axis=-1, eps=1e-5):
    m = x.mean(dim=axis, keepdim=True)
    v = x.var(dim=axis, keepdim=True, unbiased=False)
    return (x - m) / torch.sqrt(v + eps)
def _scatter_add(tgt, idx, src, axis=0):
    return tgt.clone().index_add_(axis, idx, src)
def _segment_sum(src, seg, n):
    out = torch.zeros((n,) + src.shape[1:], dtype=src.dtype)
    return out.index_add_(0, seg, src)
def _pad(x, pw):
    flat = tuple(v for pair in reversed(pw) for v in pair)
    return torch.nn.functional.pad(x, flat)

kernel_name = 'parallel_sum__linear_kernel_hedgehog__dense_activation_squared_relu__prompt'

def setup_inputs():

    _w = (lambda a: (lambda t: t.to(torch.bfloat16) if t.is_floating_point() else t)(torch.as_tensor(a)))
    def _A_setup():
        B, S, D, H = 1, 2048, 640, 32
        Dh = D // H
        return {
            "x": _w((lambda *s: torch.randn(*s, dtype=torch.bfloat16) * 0.05)(B, S, D)),
            "wqkv": _w((lambda *s: torch.randn(*s, dtype=torch.bfloat16) * 0.8)(D, 3 * D)),
            "w_phi": _w((lambda *s: torch.randn(*s, dtype=torch.bfloat16) * 0.8)(H, Dh, Dh) * (Dh ** -0.5)),
            "wo": _w((lambda *s: torch.randn(*s, dtype=torch.bfloat16) * 0.2)(D, D)),
        }
    _A_in = _A_setup()

    def _B_setup():
        B, S, D, F = 1, 2048, 640, 1536
        return {
            "x": _w((lambda *s: torch.randn(*s, dtype=torch.bfloat16) * 0.05)(B, S, D)),
            "w1": _w((lambda *s: torch.randn(*s, dtype=torch.bfloat16) * 0.05)(D, F)),
            "b1": _w((lambda *s: torch.randn(*s, dtype=torch.bfloat16) * 0.8)(F)),
            "w2": _w((lambda *s: torch.randn(*s, dtype=torch.bfloat16) * 0.05)(F, D)),
            "b2": _w((lambda *s: torch.randn(*s, dtype=torch.bfloat16) * 3.2)(D)),
        }
    _B_in = _B_setup()

    return {
        "A_x": _A_in["x"],
        "A_wqkv": _A_in["wqkv"],
        "A_w_phi": _A_in["w_phi"],
        "A_wo": _A_in["wo"],
        "B_x": _B_in["x"],
        "B_w1": _B_in["w1"],
        "B_b1": _B_in["b1"],
        "B_w2": _B_in["w2"],
        "B_b2": _B_in["b2"],
    }

def reference(A_x, A_wqkv, A_w_phi, A_wo, B_x, B_w1, B_b1, B_w2, B_b2):
    def _A_ref(x, wqkv, w_phi, wo):
        B, S, D = x.shape
        H = 32; Dh = D // H
        qkv = (lambda x, *d: x.permute(*d))((x @ wqkv).reshape(B, S, 3, H, Dh), 2, 0, 3, 1, 4)
        q, k, v = qkv[0], qkv[1], qkv[2]
        pq = torch.einsum("bhsd,hdf->bhsf", q, w_phi)
        pk = torch.einsum("bhsd,hdf->bhsf", k, w_phi)
        phi_q = torch.concatenate([_softmax(pq, axis=-1), _softmax(-pq, axis=-1)], axis=-1)
        phi_k = torch.concatenate([_softmax(pk, axis=-1), _softmax(-pk, axis=-1)], axis=-1)
        kv = torch.einsum("bhsf,bhsd->bhfd", phi_k, v)
        z  = torch.einsum("bhsf->bhf", phi_k)
        num = torch.einsum("bhqf,bhfd->bhqd", phi_q, kv)
        den = torch.einsum("bhqf,bhf->bhq", phi_q, z)[..., None] + 1e-6
        o = num / den
        return (lambda x, *d: x.permute(*d))(o, 0, 2, 1, 3).reshape(B, S, D) @ wo

    def _B_ref(x, w1, b1, w2, b2):
        h = torch.einsum("bsd,df->bsf", x, w1) + b1
        zero = torch.zeros_like(h)
        r = torch.where(h > zero, h, zero)
        h = r * r
        out = torch.einsum("bsf,fd->bsd", h, w2) + b2
        return out

    x = A_x
    xn = _layernorm(x, axis=-1)
    return x + _A_ref(xn, A_wqkv, A_w_phi, A_wo) + _B_ref(xn, B_w1, B_b1, B_w2, B_b2)
```

```asm
; @launch grid=(256,1,1) block=(512,1,1) lds=162624
.amdgcn_target "amdgcn-amd-amdhsa--gfx950"
.text
.globl parallel_sum__linear_kernel_hedgehog__dense_activation_squared_relu__prompt_kernel
.p2align 8
.type parallel_sum__linear_kernel_hedgehog__dense_activation_squared_relu__prompt_kernel,@function
parallel_sum__linear_kernel_hedgehog__dense_activation_squared_relu__prompt_kernel:
    s_load_dwordx2 s[4:5], s[0:1], 0
    s_mov_b32 s6, 2621440
    s_mov_b32 s7, 0x20000
    s_load_dwordx2 s[8:9], s[0:1], 8
    s_mov_b32 s10, 2457600
    s_mov_b32 s11, 0x20000
    s_load_dwordx2 s[12:13], s[0:1], 40
    s_mov_b32 s14, 1966080
    s_mov_b32 s15, 0x20000
    s_load_dwordx2 s[16:17], s[0:1], 88
    s_mov_b32 s18, 33554432
    s_mov_b32 s19, 0x20000
    s_load_dwordx2 s[20:21], s[0:1], 16
    s_mov_b32 s22, 25600
    s_mov_b32 s23, 0x20000
    s_load_dwordx2 s[24:25], s[0:1], 48
    s_mov_b32 s26, 3072
    s_mov_b32 s27, 0x20000
    s_load_dwordx2 s[60:61], s[0:1], 56
    s_mov_b32 s62, 1966080
    s_mov_b32 s63, 0x20000
    s_load_dwordx2 s[64:65], s[0:1], 24
    s_mov_b32 s66, 819200
    s_mov_b32 s67, 0x20000
    s_load_dwordx2 s[68:69], s[0:1], 72
    s_mov_b32 s70, 2621440
    s_mov_b32 s71, 0x20000
    s_load_dwordx2 s[72:73], s[0:1], 64
    s_mov_b32 s74, 1280
    s_mov_b32 s75, 0x20000
    s_load_dwordx2 s[76:77], s[0:1], 80
    s_mov_b32 s78, 256
    s_mov_b32 s79, 0x20000
    s_cmp_ge_u32 s2, 256
    s_cbranch_scc1 F_end
    v_lshrrev_b32 v1, 6, v0
    v_and_b32 v60, 63, v0
    s_and_b32 s33, s2, 7
    v_readfirstlane_b32 s31, v1
    s_lshr_b32 s34, s2, 3
    s_and_b32 s28, s33, 1
    s_lshl_b32 s28, s28, 3
    s_and_b32 s35, s34, 7
    s_add_u32 s28, s28, s35
    s_lshr_b32 s35, s34, 3
    s_lshr_b32 s30, s35, 1
    s_and_b32 s35, s35, 1
    s_and_b32 s29, s33, 6
    s_add_u32 s29, s29, s35
    s_mov_b32 s32, s33
    s_cmp_lt_u32 s31, 4
    s_cbranch_scc1 F_comp
F_helper:
    s_sub_u32 s31, s31, 4
    s_lshl_b32 s37, s28, 7
    s_lshl_b32 s38, s31, 5
    s_add_u32 s37, s37, s38
    v_lshrrev_b32 v2, 3, v60
    v_add_u32 v2, s37, v2
    v_mul_u32_u24 v2, 1280, v2
    v_lshrrev_b32 v3, 4, v60
    v_and_b32 v4, 7, v60
    v_xor_b32 v3, v3, v4
    v_lshl_add_u32 v10, v3, 4, v2
    v_xor_b32 v3, 4, v3
    v_lshl_add_u32 v11, v3, 4, v2
    v_add_u32 v11, 10240, v11
    v_add_u32 v12, 20480, v10
    v_add_u32 v13, 20480, v11
    s_lshl_b32 s45, s31, 12
    s_cmp_eq_u32 s30, 1
    s_cselect_b32 s46, 3, 5
    s_lshl_b32 s46, s46, 10
    s_cmp_eq_u32 s30, 1
    s_cselect_b32 s47, 4, 2
    s_lshl_b32 s47, s47, 10
    s_cmp_eq_u32 s30, 1
    s_cselect_b32 s37, 28672, 0
    s_cselect_b32 s38, 0, 36864
    s_mul_i32 s46, s46, s31
    s_add_u32 s46, s46, 16384
    s_mul_i32 s47, s47, s31
    s_add_u32 s47, s47, s37
    s_add_u32 s47, s47, s38
    s_mov_b32 s33, 45056
    s_lshl_b32 s34, s32, 7
    s_mul_i32 s35, s32, 245760
    s_mul_i32 s36, s32, 196608
    s_add_u32 s41, s33, s45
    s_add_u32 s42, s33, s46
    s_add_u32 s43, s33, s47
    s_mul_i32 s38, s29, 160
    s_waitcnt lgkmcnt(0)
    s_add_u32 m0, s41, 0
    s_nop 0
    buffer_load_dwordx4 v10, s[4:7], s34 offen lds
    s_add_u32 m0, s41, 1024
    s_nop 0
    buffer_load_dwordx4 v11, s[4:7], s34 offen lds
    s_add_u32 m0, s41, 2048
    s_nop 0
    buffer_load_dwordx4 v12, s[4:7], s34 offen lds
    s_add_u32 m0, s41, 3072
    s_nop 0
    buffer_load_dwordx4 v13, s[4:7], s34 offen lds
    s_cmp_eq_u32 s30, 1
    s_cbranch_scc1 F_hb
    s_add_u32 s38, s38, 1280
    s_lshl_b32 s39, s29, 7
    s_add_u32 s39, s39, 2048
    s_lshl_b32 s37, s31, 4
    v_lshrrev_b32 v3, 3, v60
    v_add_u32 v3, s37, v3
    v_lshrrev_b32 v4, 2, v60
    v_and_b32 v4, 4, v4
    v_and_b32 v5, 7, v60
    v_xor_b32 v4, v4, v5
    v_mul_u32_u24 v3, 3072, v3
    v_lshl_add_u32 v3, v4, 4, v3
    v_add_u32 v19, s39, v3
    s_add_u32 m0, s43, 0
    s_nop 0
    buffer_load_dwordx4 v19, s[12:15], s36 offen lds
    v_add_u32 v20, 24576, v19
    s_add_u32 m0, s43, 1024
    s_nop 0
    buffer_load_dwordx4 v20, s[12:15], s36 offen lds
    s_mul_i32 s37, s31, 61440
    s_add_u32 s38, s38, s37
    v_add_u32 v2, 0, v60
    v_mul_u32_u24 v3, 3277, v2
    v_lshrrev_b32 v3, 16, v3
    v_mul_u32_u24 v4, 20, v3
    v_sub_u32 v4, v2, v4
    v_mul_u32_u24 v5, 52, v4
    v_lshrrev_b32 v5, 8, v5
    v_mul_u32_u24 v3, 3840, v3
    v_lshl_add_u32 v3, v4, 4, v3
    v_and_b32 v6, 1, v5
    v_mul_u32_u24 v6, 1200, v6
    v_lshrrev_b32 v5, 1, v5
    v_mul_u32_u24 v5, 80, v5
    v_add3_u32 v3, v3, v6, s38
    v_sub_u32 v14, v3, v5
    s_add_u32 m0, s42, 0
    s_nop 0
    buffer_load_dwordx4 v14, s[8:11], s35 offen lds
    v_add_u32 v2, 64, v60
    v_mul_u32_u24 v3, 3277, v2
    v_lshrrev_b32 v3, 16, v3
    v_mul_u32_u24 v4, 20, v3
    v_sub_u32 v4, v2, v4
    v_mul_u32_u24 v5, 52, v4
    v_lshrrev_b32 v5, 8, v5
    v_mul_u32_u24 v3, 3840, v3
    v_lshl_add_u32 v3, v4, 4, v3
    v_and_b32 v6, 1, v5
    v_mul_u32_u24 v6, 1200, v6
    v_lshrrev_b32 v5, 1, v5
    v_mul_u32_u24 v5, 80, v5
    v_add3_u32 v3, v3, v6, s38
    v_sub_u32 v15, v3, v5
    s_add_u32 m0, s42, 1024
    s_nop 0
    buffer_load_dwordx4 v15, s[8:11], s35 offen lds
    v_add_u32 v2, 128, v60
    v_mul_u32_u24 v3, 3277, v2
    v_lshrrev_b32 v3, 16, v3
    v_mul_u32_u24 v4, 20, v3
    v_sub_u32 v4, v2, v4
    v_mul_u32_u24 v5, 52, v4
    v_lshrrev_b32 v5, 8, v5
    v_mul_u32_u24 v3, 3840, v3
    v_lshl_add_u32 v3, v4, 4, v3
    v_and_b32 v6, 1, v5
    v_mul_u32_u24 v6, 1200, v6
    v_lshrrev_b32 v5, 1, v5
    v_mul_u32_u24 v5, 80, v5
    v_add3_u32 v3, v3, v6, s38
    v_sub_u32 v16, v3, v5
    s_add_u32 m0, s42, 2048
    s_nop 0
    buffer_load_dwordx4 v16, s[8:11], s35 offen lds
    v_add_u32 v2, 192, v60
    v_mul_u32_u24 v3, 3277, v2
    v_lshrrev_b32 v3, 16, v3
    v_mul_u32_u24 v4, 20, v3
    v_sub_u32 v4, v2, v4
    v_mul_u32_u24 v5, 52, v4
    v_lshrrev_b32 v5, 8, v5
    v_mul_u32_u24 v3, 3840, v3
    v_lshl_add_u32 v3, v4, 4, v3
    v_and_b32 v6, 1, v5
    v_mul_u32_u24 v6, 1200, v6
    v_lshrrev_b32 v5, 1, v5
    v_mul_u32_u24 v5, 80, v5
    v_add3_u32 v3, v3, v6, s38
    v_sub_u32 v17, v3, v5
    s_add_u32 m0, s42, 3072
    s_nop 0
    buffer_load_dwordx4 v17, s[8:11], s35 offen lds
    v_add_u32 v2, 256, v60
    v_mul_u32_u24 v3, 3277, v2
    v_lshrrev_b32 v3, 16, v3
    v_mul_u32_u24 v4, 20, v3
    v_sub_u32 v4, v2, v4
    v_mul_u32_u24 v5, 52, v4
    v_lshrrev_b32 v5, 8, v5
    v_mul_u32_u24 v3, 3840, v3
    v_lshl_add_u32 v3, v4, 4, v3
    v_and_b32 v6, 1, v5
    v_mul_u32_u24 v6, 1200, v6
    v_lshrrev_b32 v5, 1, v5
    v_mul_u32_u24 v5, 80, v5
    v_add3_u32 v3, v3, v6, s38
    v_sub_u32 v18, v3, v5
    s_add_u32 m0, s42, 4096
    s_nop 0
    buffer_load_dwordx4 v18, s[8:11], s35 offen lds
    v_mov_b32 v21, v19
    v_mov_b32 v22, v19
    s_branch F_hc
F_hb:
    s_lshl_b32 s39, s29, 8
    s_lshl_b32 s37, s31, 4
    v_lshrrev_b32 v3, 4, v60
    v_lshlrev_b32 v4, 2, v3
    v_add_u32 v3, s37, v3
    v_and_b32 v5, 15, v60
    v_xor_b32 v4, v4, v5
    v_mul_u32_u24 v3, 3072, v3
    v_lshl_add_u32 v3, v4, 4, v3
    v_add_u32 v19, s39, v3
    s_add_u32 m0, s43, 0
    s_nop 0
    buffer_load_dwordx4 v19, s[12:15], s36 offen lds
    v_add_u32 v20, 12288, v19
    s_add_u32 m0, s43, 1024
    s_nop 0
    buffer_load_dwordx4 v20, s[12:15], s36 offen lds
    v_add_u32 v21, 24576, v19
    s_add_u32 m0, s43, 2048
    s_nop 0
    buffer_load_dwordx4 v21, s[12:15], s36 offen lds
    v_add_u32 v22, 36864, v19
    s_add_u32 m0, s43, 3072
    s_nop 0
    buffer_load_dwordx4 v22, s[12:15], s36 offen lds
    s_mul_i32 s37, s31, 61440
    s_add_u32 s38, s38, s37
    v_add_u32 v2, 0, v60
    v_mul_u32_u24 v3, 5462, v2
    v_lshrrev_b32 v3, 16, v3
    v_mul_u32_u24 v4, 12, v3
    v_sub_u32 v4, v2, v4
    v_mul_u32_u24 v5, 43, v4
    v_lshrrev_b32 v5, 8, v5
    v_sub_u32 v6, v4, v5
    v_mul_u32_u24 v3, 3840, v3
    v_lshl_add_u32 v3, v6, 4, v3
    v_add_u32 v14, s38, v3
    s_add_u32 m0, s42, 0
    s_nop 0
    buffer_load_dwordx4 v14, s[8:11], s35 offen lds
    v_add_u32 v2, 64, v60
    v_mul_u32_u24 v3, 5462, v2
    v_lshrrev_b32 v3, 16, v3
    v_mul_u32_u24 v4, 12, v3
    v_sub_u32 v4, v2, v4
    v_mul_u32_u24 v5, 43, v4
    v_lshrrev_b32 v5, 8, v5
    v_sub_u32 v6, v4, v5
    v_mul_u32_u24 v3, 3840, v3
    v_lshl_add_u32 v3, v6, 4, v3
    v_add_u32 v15, s38, v3
    s_add_u32 m0, s42, 1024
    s_nop 0
    buffer_load_dwordx4 v15, s[8:11], s35 offen lds
    v_add_u32 v2, 128, v60
    v_mul_u32_u24 v3, 5462, v2
    v_lshrrev_b32 v3, 16, v3
    v_mul_u32_u24 v4, 12, v3
    v_sub_u32 v4, v2, v4
    v_mul_u32_u24 v5, 43, v4
    v_lshrrev_b32 v5, 8, v5
    v_sub_u32 v6, v4, v5
    v_mul_u32_u24 v3, 3840, v3
    v_lshl_add_u32 v3, v6, 4, v3
    v_add_u32 v16, s38, v3
    s_add_u32 m0, s42, 2048
    s_nop 0
    buffer_load_dwordx4 v16, s[8:11], s35 offen lds
    v_mov_b32 v17, v14
    v_mov_b32 v18, v14
F_hc:
    s_add_u32 s32, s32, 1
    s_cmp_eq_u32 s32, 10
    s_cselect_b32 s32, 0, s32
    s_add_u32 s33, s33, 45056
    s_cmp_eq_u32 s33, 135168
    s_cselect_b32 s33, 0, s33
    s_call_b64 s[56:57], F_issue
    s_mov_b32 s40, s2
    s_mov_b32 s44, s31
    s_cmp_lt_u32 s31, 2
    s_cselect_b32 s58, 1, 0
    s_cbranch_scc1 F_wt_sel
    s_and_b32 s44, s2, 1
    s_lshr_b32 s40, s2, 1
    s_add_u32 s40, s40, 144
    s_cmp_eq_u32 s31, 2
    s_cselect_b32 s58, 1, 0
    s_cmp_ge_u32 s2, 224
    s_cselect_b32 s58, s58, 0
F_wt_sel:
    s_mul_i32 s49, s31, 5120
    s_add_u32 s49, s49, 147200
    v_mov_b32 v62, 0
    v_mov_b32 v63, 0
    s_cmp_eq_u32 s58, 0
    s_cbranch_scc1 F_wt_skip1
    s_lshr_b32 s50, s40, 2
    s_and_b32 s51, s40, 3
    s_lshl_b32 s51, s51, 1
    s_add_u32 s51, s51, s44
    s_mul_i32 s52, s51, 160
    v_add_u32 v62, 0, v60
    v_mul_u32_u24 v63, 6554, v62
    v_lshrrev_b32 v63, 16, v63
    v_mul_u32_u24 v63, 1120, v63
    v_lshl_add_u32 v23, v62, 4, v63
    v_add_u32 v62, 64, v60
    v_mul_u32_u24 v63, 6554, v62
    v_lshrrev_b32 v63, 16, v63
    v_mul_u32_u24 v63, 1120, v63
    v_lshl_add_u32 v24, v62, 4, v63
    v_add_u32 v62, 128, v60
    v_mul_u32_u24 v63, 6554, v62
    v_lshrrev_b32 v63, 16, v63
    v_mul_u32_u24 v63, 1120, v63
    v_lshl_add_u32 v25, v62, 4, v63
    v_add_u32 v62, 192, v60
    v_mul_u32_u24 v63, 6554, v62
    v_lshrrev_b32 v63, 16, v63
    v_mul_u32_u24 v63, 1120, v63
    v_lshl_add_u32 v26, v62, 4, v63
    v_add_u32 v62, 256, v60
    v_mul_u32_u24 v63, 6554, v62
    v_lshrrev_b32 v63, 16, v63
    v_mul_u32_u24 v63, 1120, v63
    v_lshl_add_u32 v27, v62, 4, v63
    s_cmp_ge_u32 s50, 48
    s_cbranch_scc1 FW_wo
    s_mul_i32 s53, s50, 40960
    s_add_u32 s53, s53, s52
    s_add_u32 m0, s49, 0
    s_nop 0
    buffer_load_dwordx4 v23, s[60:63], s53 offen lds
    s_add_u32 m0, s49, 1024
    s_nop 0
    buffer_load_dwordx4 v24, s[60:63], s53 offen lds
    s_add_u32 m0, s49, 2048
    s_nop 0
    buffer_load_dwordx4 v25, s[60:63], s53 offen lds
    s_add_u32 m0, s49, 3072
    s_nop 0
    buffer_load_dwordx4 v26, s[60:63], s53 offen lds
    s_add_u32 m0, s49, 4096
    s_nop 0
    buffer_load_dwordx4 v27, s[60:63], s53 offen lds
    s_branch FW_go
FW_wo:
    s_sub_u32 s53, s50, 48
    s_mul_i32 s53, s53, 40960
    s_add_u32 s53, s53, s52
    s_add_u32 m0, s49, 0
    s_nop 0
    buffer_load_dwordx4 v23, s[64:67], s53 offen lds
    s_add_u32 m0, s49, 1024
    s_nop 0
    buffer_load_dwordx4 v24, s[64:67], s53 offen lds
    s_add_u32 m0, s49, 2048
    s_nop 0
    buffer_load_dwordx4 v25, s[64:67], s53 offen lds
    s_add_u32 m0, s49, 3072
    s_nop 0
    buffer_load_dwordx4 v26, s[64:67], s53 offen lds
    s_add_u32 m0, s49, 4096
    s_nop 0
    buffer_load_dwordx4 v27, s[64:67], s53 offen lds
FW_go:
    v_bfe_u32 v62, v60, 2, 2
    v_lshrrev_b32 v63, 4, v60
    v_lshl_add_u32 v62, v63, 3, v62
    v_mul_u32_u24 v62, 160, v62
    v_and_b32 v63, 3, v60
    v_mul_u32_u24 v63, 40, v63
    v_add3_u32 v62, v62, v63, s49
    s_mul_i32 s54, s51, 68
    s_add_u32 s54, s54, s50
    s_mul_i32 s54, s54, 5120
    s_add_u32 s54, s54, 18874368
    s_add_u32 s55, s54, 4096
    v_lshlrev_b32 v63, 4, v60
F_wt_skip1:
    s_lshl_b32 s37, s29, 2
    s_add_u32 s37, s37, s31
    s_mul_i32 s37, s37, 800
    v_lshlrev_b32 v2, 3, v60
    buffer_load_dwordx2 v[30:31], v2, s[20:23], s37 offen
    buffer_load_dwordx2 v[32:33], v2, s[20:23], s37 offen offset:512
    v_mov_b32 v56, 0
    v_mov_b32 v57, 0
    v_mov_b32 v58, 0
    v_mov_b32 v59, 0
    s_mul_i32 s37, s31, 2880
    s_add_u32 s37, s37, 135168
    v_lshl_add_u32 v2, v60, 4, s37
    ds_write_b128 v2, v[56:59]
    ds_write_b128 v2, v[56:59] offset:1024
    ds_write_b128 v2, v[56:59] offset:1856
    v_lshlrev_b32 v61, 2, v60
    v_min_u32 v2, 60, v61
    v_add_u32 v2, 162560, v2
    ds_write_b32 v2, v56
    v_mov_b32 v50, 0
    v_mov_b32 v51, 0
    s_cmp_eq_u32 s31, 3
    s_cbranch_scc0 F_ca2
    s_cmp_eq_u32 s30, 1
    s_cbranch_scc1 F_ca1
    v_mul_u32_u24 v2, 26, v60
    v_lshrrev_b32 v2, 8, v2
    v_mul_u32_u24 v3, 10, v2
    v_sub_u32 v3, v60, v3
    v_and_b32 v4, 1, v2
    v_mul_u32_u24 v4, 640, v4
    v_lshrrev_b32 v2, 1, v2
    v_mul_u32_u24 v2, 40, v2
    v_lshl_add_u32 v2, v3, 2, v2
    s_mul_i32 s37, s29, 80
    s_add_u32 s37, s37, 640
    v_add3_u32 v2, v2, v4, s37
    s_lshl_b32 s37, s29, 6
    s_add_u32 s37, s37, 864
    v_lshl_add_u32 v3, v60, 2, s37
    v_add_u32 v4, 1920, v3
    v_lshlrev_b32 v3, 1, v3
    v_mov_b32 v5, 0x40000000
    v_cmp_gt_u32 vcc, 40, v60
    v_mov_b32 v6, 126656
    v_mov_b32 v7, 106496
    v_cndmask_b32 v2, v4, v2, vcc
    v_cndmask_b32 v51, v3, v5, vcc
    v_cndmask_b32 v6, v6, v7, vcc
    v_lshl_add_u32 v6, v60, 3, v6
    v_mov_b32 v7, 128
    v_mov_b32 v8, 320
    v_cndmask_b32 v7, v7, v8, vcc
    v_mov_b32 v8, 64
    v_cndmask_b32 v8, v8, v56, vcc
    v_lshlrev_b32 v50, 2, v2
    v_mul_u32_u24 v40, 0, v8
    v_xor_b32 v40, v40, v6
    v_mad_u32_u24 v40, v7, 0, v40
    v_mul_u32_u24 v41, 0, v8
    v_xor_b32 v41, v41, v6
    v_mad_u32_u24 v41, v7, 1, v41
    v_mul_u32_u24 v42, 1, v8
    v_xor_b32 v42, v42, v6
    v_mad_u32_u24 v42, v7, 2, v42
    v_mul_u32_u24 v43, 1, v8
    v_xor_b32 v43, v43, v6
    v_mad_u32_u24 v43, v7, 3, v43
    v_mul_u32_u24 v44, 0, v8
    v_xor_b32 v44, v44, v6
    v_mad_u32_u24 v44, v7, 4, v44
    s_branch F_ca2
F_ca1:
    v_mul_u32_u24 v2, 22, v60
    v_lshrrev_b32 v2, 8, v2
    v_lshlrev_b32 v2, 1, v2
    v_sub_u32 v2, v60, v2
    s_mul_i32 s37, s29, 80
    v_lshl_add_u32 v2, v2, 2, s37
    s_lshl_b32 s37, s29, 7
    s_sub_u32 s37, s37, 96
    v_lshl_add_u32 v3, v60, 2, s37
    v_add_u32 v4, 1920, v3
    v_lshlrev_b32 v3, 1, v3
    v_mov_b32 v5, 0x40000000
    v_cmp_gt_u32 vcc, 24, v60
    v_mov_b32 v6, 118592
    v_mov_b32 v7, 106496
    v_cndmask_b32 v2, v4, v2, vcc
    v_cndmask_b32 v51, v3, v5, vcc
    v_cndmask_b32 v6, v6, v7, vcc
    v_lshl_add_u32 v6, v60, 3, v6
    v_mov_b32 v7, 256
    v_mov_b32 v8, 192
    v_cndmask_b32 v7, v7, v8, vcc
    v_mov_b32 v8, 64
    v_cndmask_b32 v8, v8, v56, vcc
    v_lshlrev_b32 v50, 2, v2
    v_mul_u32_u24 v40, 0, v8
    v_xor_b32 v40, v40, v6
    v_mad_u32_u24 v40, v7, 0, v40
    v_mul_u32_u24 v41, 1, v8
    v_xor_b32 v41, v41, v6
    v_mad_u32_u24 v41, v7, 1, v41
    v_mul_u32_u24 v42, 2, v8
    v_xor_b32 v42, v42, v6
    v_mad_u32_u24 v42, v7, 2, v42
    v_mul_u32_u24 v43, 3, v8
    v_xor_b32 v43, v43, v6
    v_mad_u32_u24 v43, v7, 3, v43
    v_mul_u32_u24 v44, 0, v8
    v_xor_b32 v44, v44, v6
    v_mad_u32_u24 v44, v7, 4, v44
F_ca2:
    v_mov_b32 v49, 162592
    s_mov_b32 s40, 204800
    s_cmp_eq_u32 s58, 1
    s_cbranch_scc1 F_wt_j1
    s_waitcnt vmcnt(13)
F_wt_j1:
    s_waitcnt vmcnt(18) lgkmcnt(0)
    s_barrier
    s_call_b64 s[56:57], F_issue
    s_waitcnt vmcnt(13)
    s_barrier
    s_cmp_eq_u32 s58, 0
    s_cbranch_scc1 F_wt_skip2
    ds_read_b64_tr_b16 v[64:65], v62 offset:0
    ds_read_b64_tr_b16 v[66:67], v62 offset:640
    ds_read_b64_tr_b16 v[68:69], v62 offset:8
    ds_read_b64_tr_b16 v[70:71], v62 offset:648
    ds_read_b64_tr_b16 v[72:73], v62 offset:16
    ds_read_b64_tr_b16 v[74:75], v62 offset:656
    ds_read_b64_tr_b16 v[76:77], v62 offset:24
    ds_read_b64_tr_b16 v[78:79], v62 offset:664
    ds_read_b64_tr_b16 v[80:81], v62 offset:32
    ds_read_b64_tr_b16 v[82:83], v62 offset:672
    s_call_b64 s[56:57], F_issue
    s_waitcnt lgkmcnt(0)
    buffer_store_dwordx4 v[64:67], v63, s[16:19], s54 offen offset:0 sc1
    buffer_store_dwordx4 v[68:71], v63, s[16:19], s54 offen offset:1024 sc1
    buffer_store_dwordx4 v[72:75], v63, s[16:19], s54 offen offset:2048 sc1
    buffer_store_dwordx4 v[76:79], v63, s[16:19], s54 offen offset:3072 sc1
    buffer_store_dwordx4 v[80:83], v63, s[16:19], s55 offen offset:0 sc1
    s_waitcnt vmcnt(16)
    s_branch F_wt_j2
F_wt_skip2:
    s_buffer_load_dword s53, s[76:79], 0
    s_call_b64 s[56:57], F_issue
    s_cmp_eq_u32 s31, 3
    s_cbranch_scc0 F_ng_x
    s_mov_b32 s48, 0
    s_waitcnt lgkmcnt(0)
    s_cmp_eq_u32 s53, 0
    s_cbranch_scc0 F_ng_y
F_ng:
    s_buffer_load_dword s53, s[76:79], 0 glc
    s_add_u32 s48, s48, 1
    s_waitcnt lgkmcnt(0)
    s_cmp_ge_u32 s48, 262144
    s_cbranch_scc1 F_ng_y
    s_cmp_eq_u32 s53, 0
    s_cbranch_scc1 F_ng
F_ng_y:
    v_mov_b32 v2, s53
    ds_write_b32 v49, v2
F_ng_x:
    s_waitcnt vmcnt(11) lgkmcnt(0)
F_wt_j2:
    s_barrier
    s_call_b64 s[56:57], F_issue
    s_waitcnt vmcnt(11)
    s_barrier
    s_call_b64 s[56:57], F_issue
    s_waitcnt vmcnt(11)
    s_barrier
    s_call_b64 s[56:57], F_issue
    s_sub_u32 s37, s31, 1
    s_lshl_b32 s37, s37, 6
    v_add_u32 v2, s37, v60
    v_and_b32 v2, 127, v2
    v_lshlrev_b32 v45, 3, v2
    v_lshlrev_b32 v46, 7, v2
    v_and_b32 v7, 14, v2
    v_lshl_add_u32 v46, v7, 3, v46
    v_add_u32 v46, 90112, v46
    v_xor_b32 v47, 16, v46
    v_lshlrev_b32 v48, 2, v2
    v_add_u32 v48, 146688, v48
    v_lshrrev_b32 v61, 2, v60
    v_lshlrev_b32 v61, 7, v61
    v_and_b32 v3, 3, v60
    v_lshl_add_u32 v61, v3, 4, v61
    s_waitcnt vmcnt(11)
    s_barrier
    s_call_b64 s[56:57], F_issue
    s_waitcnt vmcnt(11)
    s_barrier
    s_cmp_eq_u32 s31, 3
    s_cbranch_scc1 F_pl
    s_call_b64 s[56:57], F_issue
    s_waitcnt vmcnt(11)
    s_branch F_pollx
F_pl:
    buffer_load_dwordx4 v[36:39], v61, s[16:19], s40 offen sc1
    s_call_b64 s[56:57], F_issue
    s_mov_b32 s48, 0
    s_waitcnt vmcnt(11)
F_poll:
    v_min3_u32 v2, v36, v37, v38
    v_max3_u32 v3, v36, v37, v38
    v_min_u32 v2, v2, v39
    v_max_u32 v3, v3, v39
    v_cmp_eq_u32 s[38:39], s53, v2
    v_cmp_eq_u32 vcc, s53, v3
    s_and_b64 vcc, vcc, s[38:39]
    s_add_u32 s48, s48, 1
    s_cmp_ge_u32 s48, 262144
    s_cbranch_scc1 F_pollx
    s_cmp_eq_u64 vcc, -1
    s_cbranch_scc1 F_pollx
    buffer_load_dwordx4 v[36:39], v61, s[16:19], s40 offen sc1
    s_waitcnt vmcnt(0)
    s_branch F_poll
F_pollx:
    s_barrier
    s_cmp_eq_u32 s31, 3
    s_cbranch_scc1 F_ldc
    s_lshl_b32 s38, s28, 10
    buffer_load_dwordx2 v[64:65], v45, s[16:19], s38 offen sc1
    s_call_b64 s[56:57], F_issue
    s_waitcnt vmcnt(12)
    s_branch F_ldx
F_ldc:
    s_mov_b32 s37, 32768
    buffer_load_dwordx4 v[64:67], v50, s[16:19], s37 offen sc1
    s_add_u32 s37, s37, 13824
    buffer_load_dwordx4 v[68:71], v50, s[16:19], s37 offen sc1
    s_add_u32 s37, s37, 13824
    buffer_load_dwordx4 v[72:75], v50, s[16:19], s37 offen sc1
    s_add_u32 s37, s37, 13824
    buffer_load_dwordx4 v[76:79], v50, s[16:19], s37 offen sc1
    s_add_u32 s37, s37, 13824
    buffer_load_dwordx4 v[80:83], v50, s[16:19], s37 offen sc1
    s_add_u32 s37, s37, 13824
    buffer_load_dwordx4 v[84:87], v50, s[16:19], s37 offen sc1
    s_add_u32 s37, s37, 13824
    buffer_load_dwordx4 v[88:91], v50, s[16:19], s37 offen sc1
    s_add_u32 s37, s37, 13824
    buffer_load_dwordx4 v[92:95], v50, s[16:19], s37 offen sc1
    s_add_u32 s37, s37, 13824
    buffer_load_dwordx2 v[52:53], v51, s[24:27], 0 offen
    s_call_b64 s[56:57], F_issue
    s_waitcnt vmcnt(20)
F_ldx:
    s_barrier
    ds_read_b32 v36, v49
    s_and_b32 s37, s31, 1
    s_mul_i32 s37, s37, 1960
    s_lshr_b32 s38, s31, 1
    s_mul_i32 s38, s38, 3840
    s_add_u32 s37, s37, s38
    s_add_u32 s37, s37, 135168
    v_mul_u32_u24 v2, 205, v60
    v_lshrrev_b32 v2, 10, v2
    v_mul_u32_u24 v2, 56, v2
    v_lshl_add_u32 v2, v60, 3, v2
    v_add_u32 v28, s37, v2
    v_add_u32 v3, 64, v60
    v_mul_u32_u24 v2, 205, v3
    v_lshrrev_b32 v2, 10, v2
    v_mul_u32_u24 v2, 56, v2
    v_lshl_add_u32 v2, v3, 3, v2
    v_add_u32 v29, s37, v2
    ds_write_b64 v28, v[30:31]
    v_cmp_gt_u32 vcc, 36, v60
    s_and_saveexec_b64 s[48:49], vcc
    ds_write_b64 v29, v[32:33]
    s_mov_b64 exec, -1
    s_mov_b32 s39, 0xffff0000
    s_and_b32 s36, s2, 7
    s_lshr_b32 s37, s2, 3
    s_lshr_b32 s28, s36, 1
    s_lshl_b32 s28, s28, 3
    s_and_b32 s38, s37, 7
    s_add_u32 s28, s28, s38
    s_and_b32 s29, s36, 1
    s_lshl_b32 s29, s29, 2
    s_lshr_b32 s38, s37, 3
    s_add_u32 s29, s29, s38
    v_mov_b32 v14, v60
    v_lshlrev_b32 v6, 4, v14
    v_add_u32 v7, 4096, v6
    s_lshl_b32 s32, s28, 2
    s_mul_i32 s32, s32, 69632
    s_lshl_b32 s34, s31, 10
    s_add_u32 s32, s32, s34
    s_add_u32 s32, s32, 8388608
    s_mul_i32 s33, s29, 68
    s_add_u32 s33, s33, s31
    s_mul_i32 s33, s33, 5120
    s_add_u32 s33, s33, 18874368
    s_add_u32 s34, s31, 0
    s_and_b32 s34, s34, 3
    s_mul_i32 s34, s34, 69632
    v_add_u32 v2, s34, v6
    s_add_u32 s34, s31, 1
    s_and_b32 s34, s34, 3
    s_mul_i32 s34, s34, 69632
    v_add_u32 v3, s34, v6
    s_add_u32 s34, s31, 2
    s_and_b32 s34, s34, 3
    s_mul_i32 s34, s34, 69632
    v_add_u32 v4, s34, v6
    s_add_u32 s34, s31, 3
    s_and_b32 s34, s34, 3
    s_mul_i32 s34, s34, 69632
    v_add_u32 v5, s34, v6
    buffer_load_dwordx4 v[96:99], v6, s[16:19], s33 offen offset:0 sc1
    buffer_load_dwordx4 v[100:103], v6, s[16:19], s33 offen offset:1024 sc1
    buffer_load_dwordx4 v[104:107], v6, s[16:19], s33 offen offset:2048 sc1
    buffer_load_dwordx4 v[108:111], v6, s[16:19], s33 offen offset:3072 sc1
    buffer_load_dwordx4 v[112:115], v7, s[16:19], s33 offen offset:0 sc1
    s_add_u32 s33, s33, 20480
    buffer_load_dwordx4 v[116:119], v6, s[16:19], s33 offen offset:0 sc1
    buffer_load_dwordx4 v[120:123], v6, s[16:19], s33 offen offset:1024 sc1
    buffer_load_dwordx4 v[124:127], v6, s[16:19], s33 offen offset:2048 sc1
    buffer_load_dwordx4 v[128:131], v6, s[16:19], s33 offen offset:3072 sc1
    buffer_load_dwordx4 v[132:135], v7, s[16:19], s33 offen offset:0 sc1
    s_add_u32 s33, s33, 20480
    s_lshl_b32 s34, s28, 2
    s_add_u32 s34, s34, s31
    s_mul_i32 s34, s34, 20480
    s_mul_i32 s35, s29, 160
    s_add_u32 s34, s34, s35
    v_and_b32 v8, 15, v14
    v_mul_u32_u24 v8, 1280, v8
    v_lshrrev_b32 v9, 4, v14
    v_mul_u32_u24 v9, 40, v9
    v_add_u32 v8, v8, v9
    s_mul_i32 s37, s31, 5120
    s_add_u32 s57, s31, 1
    s_mul_i32 s58, s57, 20480
    s_lshl_b32 s57, s57, 12
    s_lshr_b32 s55, s28, 1
    s_lshl_b32 s55, s55, 2
    s_add_u32 s55, s55, s31
    s_lshl_b32 s55, s55, 8
    s_add_u32 s55, s55, 2162688
    s_waitcnt lgkmcnt(0)
    v_readfirstlane_b32 s53, v36
    s_cmp_eq_u32 s31, 3
    s_waitcnt vmcnt(21)
    s_cbranch_scc1 F_prc
    s_cmp_eq_u32 s31, 0
    s_cbranch_scc1 F_prx
    v_rcp_f32 v66, v65
    v_sub_f32 v64, 0, v64
    v_cvt_pk_bf16_f32 v68, v64, v64
    v_and_b32 v67, s39, v68
    v_sub_f32 v64, v64, v67
    v_cvt_pk_bf16_f32 v69, v64, v66
    v_and_b32 v67, s39, v69
    v_sub_f32 v66, v66, v67
    v_cvt_pk_bf16_f32 v70, v66, v56
    v_mov_b32 v71, 0
    ds_write_b128 v46, v[68:71]
    ds_write_b128 v47, v[56:59]
    ds_write_b32 v48, v65
    s_branch F_prx
F_prc:
    v_pk_add_f32 v[64:65], v[64:65], v[68:69]
    v_pk_add_f32 v[66:67], v[66:67], v[70:71]
    v_pk_add_f32 v[64:65], v[64:65], v[72:73]
    v_pk_add_f32 v[66:67], v[66:67], v[74:75]
    v_pk_add_f32 v[64:65], v[64:65], v[76:77]
    v_pk_add_f32 v[66:67], v[66:67], v[78:79]
    v_pk_add_f32 v[64:65], v[64:65], v[80:81]
    v_pk_add_f32 v[66:67], v[66:67], v[82:83]
    v_pk_add_f32 v[64:65], v[64:65], v[84:85]
    v_pk_add_f32 v[66:67], v[66:67], v[86:87]
    v_pk_add_f32 v[64:65], v[64:65], v[88:89]
    v_pk_add_f32 v[66:67], v[66:67], v[90:91]
    v_pk_add_f32 v[64:65], v[64:65], v[92:93]
    v_pk_add_f32 v[66:67], v[66:67], v[94:95]
    v_cvt_pk_bf16_f32 v70, v64, v65
    v_cvt_pk_bf16_f32 v71, v66, v67
    v_lshlrev_b32 v72, 16, v70
    v_and_b32 v73, s39, v70
    v_lshlrev_b32 v74, 16, v71
    v_and_b32 v75, s39, v71
    v_sub_f32 v64, v64, v72
    v_sub_f32 v65, v65, v73
    v_sub_f32 v66, v66, v74
    v_sub_f32 v67, v67, v75
    v_cvt_pk_bf16_f32 v72, v64, v65
    v_cvt_pk_bf16_f32 v73, v66, v67
    v_cmp_gt_u32 vcc, 56, v60
    s_and_saveexec_b64 s[48:49], vcc
    ds_write_b64 v40, v[70:71]
    ds_write_b64 v41, v[72:73]
    ds_write_b64 v42, v[70:71]
    ds_write_b64 v43, v[52:53]
    ds_write_b64 v44, v[52:53]
    s_mov_b64 exec, -1
F_prx:
    s_waitcnt vmcnt(10)
    s_barrier
    s_lshl2_add_u32 s48, s30, s31
    s_cmp_eq_u32 s48, 3
    s_cbranch_scc1 F_d3a
    buffer_load_dwordx4 v[136:139], v6, s[16:19], s33 offen offset:0 sc1
    buffer_load_dwordx4 v[140:143], v6, s[16:19], s33 offen offset:1024 sc1
    buffer_load_dwordx4 v[144:147], v6, s[16:19], s33 offen offset:2048 sc1
    buffer_load_dwordx4 v[148:151], v6, s[16:19], s33 offen offset:3072 sc1
    buffer_load_dwordx4 v[152:155], v7, s[16:19], s33 offen offset:0 sc1
    s_add_u32 s33, s33, 20480
    buffer_load_dwordx4 v[156:159], v6, s[16:19], s33 offen offset:0 sc1
    buffer_load_dwordx4 v[160:163], v6, s[16:19], s33 offen offset:1024 sc1
    buffer_load_dwordx4 v[164:167], v6, s[16:19], s33 offen offset:2048 sc1
    buffer_load_dwordx4 v[168:171], v6, s[16:19], s33 offen offset:3072 sc1
    buffer_load_dwordx4 v[172:175], v7, s[16:19], s33 offen offset:0 sc1
    s_add_u32 s33, s33, 20480
    s_add_u32 m0, s37, 0
    s_nop 0
    buffer_load_dwordx4 v6, s[16:19], s33 offen offset:0 sc1 lds
    buffer_load_dwordx4 v6, s[16:19], s33 offen offset:1024 sc1 lds
    buffer_load_dwordx4 v6, s[16:19], s33 offen offset:2048 sc1 lds
    buffer_load_dwordx4 v6, s[16:19], s33 offen offset:3072 sc1 lds
    s_add_u32 m0, s37, 4096
    s_nop 0
    buffer_load_dwordx4 v7, s[16:19], s33 offen sc1 lds
    s_add_u32 s33, s33, 20480
    s_add_u32 m0, s37, 20480
    s_nop 0
    buffer_load_dwordx4 v6, s[16:19], s33 offen offset:0 sc1 lds
    buffer_load_dwordx4 v6, s[16:19], s33 offen offset:1024 sc1 lds
    buffer_load_dwordx4 v6, s[16:19], s33 offen offset:2048 sc1 lds
    buffer_load_dwordx4 v6, s[16:19], s33 offen offset:3072 sc1 lds
    s_add_u32 m0, s37, 24576
    s_nop 0
    buffer_load_dwordx4 v7, s[16:19], s33 offen sc1 lds
    s_add_u32 s33, s33, 20480
F_d3a:
    v_add_u32 v15, s37, v6
    v_add_u32 v13, 61440, v15
    v_add_u32 v1, 112640, v15
    s_waitcnt lgkmcnt(0)
    s_barrier
    s_barrier
    s_lshl2_add_u32 s48, s30, s31
    s_cmp_eq_u32 s48, 3
    s_cbranch_scc0 F_d3b
    buffer_load_dwordx4 v[136:139], v6, s[16:19], s33 offen offset:0 sc1
    buffer_load_dwordx4 v[140:143], v6, s[16:19], s33 offen offset:1024 sc1
    buffer_load_dwordx4 v[144:147], v6, s[16:19], s33 offen offset:2048 sc1
    buffer_load_dwordx4 v[148:151], v6, s[16:19], s33 offen offset:3072 sc1
    buffer_load_dwordx4 v[152:155], v7, s[16:19], s33 offen offset:0 sc1
    s_add_u32 s33, s33, 20480
    buffer_load_dwordx4 v[156:159], v6, s[16:19], s33 offen offset:0 sc1
    buffer_load_dwordx4 v[160:163], v6, s[16:19], s33 offen offset:1024 sc1
    buffer_load_dwordx4 v[164:167], v6, s[16:19], s33 offen offset:2048 sc1
    buffer_load_dwordx4 v[168:171], v6, s[16:19], s33 offen offset:3072 sc1
    buffer_load_dwordx4 v[172:175], v7, s[16:19], s33 offen offset:0 sc1
    s_add_u32 s33, s33, 20480
    s_add_u32 m0, s37, 0
    s_nop 0
    buffer_load_dwordx4 v6, s[16:19], s33 offen offset:0 sc1 lds
    buffer_load_dwordx4 v6, s[16:19], s33 offen offset:1024 sc1 lds
    buffer_load_dwordx4 v6, s[16:19], s33 offen offset:2048 sc1 lds
    buffer_load_dwordx4 v6, s[16:19], s33 offen offset:3072 sc1 lds
    s_add_u32 m0, s37, 4096
    s_nop 0
    buffer_load_dwordx4 v7, s[16:19], s33 offen sc1 lds
    s_add_u32 s33, s33, 20480
    s_add_u32 m0, s37, 20480
    s_nop 0
    buffer_load_dwordx4 v6, s[16:19], s33 offen offset:0 sc1 lds
    buffer_load_dwordx4 v6, s[16:19], s33 offen offset:1024 sc1 lds
    buffer_load_dwordx4 v6, s[16:19], s33 offen offset:2048 sc1 lds
    buffer_load_dwordx4 v6, s[16:19], s33 offen offset:3072 sc1 lds
    s_add_u32 m0, s37, 24576
    s_nop 0
    buffer_load_dwordx4 v7, s[16:19], s33 offen sc1 lds
    s_add_u32 s33, s33, 20480
F_d3b:
    v_mov_b32 v11, 162560
    s_mov_b32 s48, 0
spin_1:
    ds_read_b32 v12, v11
    s_add_u32 s48, s48, 1
    s_waitcnt lgkmcnt(0)
    v_readfirstlane_b32 s47, v12
    s_cmp_ge_u32 s48, 262144
    s_cbranch_scc1 spin_1_x
    s_cmp_lt_u32 s47, 4
    s_cbranch_scc1 spin_1
spin_1_x:
F_p2:
    s_cmp_eq_u32 s30, 1
    s_cbranch_scc1 F_p2_1
F_p2_0:
    s_add_u32 m0, s37, 112640
    s_nop 0
    buffer_load_dwordx4 v6, s[16:19], s33 offen offset:0 sc1 lds
    buffer_load_dwordx4 v6, s[16:19], s33 offen offset:1024 sc1 lds
    buffer_load_dwordx4 v6, s[16:19], s33 offen offset:2048 sc1 lds
    buffer_load_dwordx4 v6, s[16:19], s33 offen offset:3072 sc1 lds
    s_add_u32 m0, s37, 116736
    s_nop 0
    buffer_load_dwordx4 v7, s[16:19], s33 offen sc1 lds
    s_add_u32 s33, s33, 20480
    s_add_u32 m0, s37, 133120
    s_nop 0
    buffer_load_dwordx4 v6, s[16:19], s33 offen offset:0 sc1 lds
    buffer_load_dwordx4 v6, s[16:19], s33 offen offset:1024 sc1 lds
    buffer_load_dwordx4 v6, s[16:19], s33 offen offset:2048 sc1 lds
    buffer_load_dwordx4 v6, s[16:19], s33 offen offset:3072 sc1 lds
    s_add_u32 m0, s37, 137216
    s_nop 0
    buffer_load_dwordx4 v7, s[16:19], s33 offen sc1 lds
    s_add_u32 s33, s33, 20480
    s_lshr_b32 s54, s28, 1
    s_lshl_b32 s54, s54, 11
    s_add_u32 s54, s54, 2097152
    s_mov_b64 s[38:39], 0xff00
    s_mov_b64 s[40:41], 0xff
    s_cmp_eq_u32 s31, 0
    s_cbranch_scc0 F_p2_wait0
    v_lshlrev_b32 v10, 7, v14
    s_mov_b32 s48, 0
    s_mov_b64 exec, s[38:39]
poll_2:
    buffer_load_dword v11, v10, s[16:19], s54 offen sc1
    s_add_u32 s48, s48, 1
    s_waitcnt vmcnt(0)
    v_cmp_eq_u32 vcc, s53, v11
    s_cmp_ge_u32 s48, 262144
    s_cbranch_scc1 poll_2_x
    s_cmp_eq_u64 vcc, s[38:39]
    s_cbranch_scc0 poll_2
poll_2_x:
    s_mov_b64 exec, -1
    v_mov_b32 v10, 1
    v_mov_b32 v11, 162584
    ds_write_b32 v11, v10
    s_waitcnt lgkmcnt(0)
F_p2_wait0:
    v_mov_b32 v11, 162584
    s_mov_b32 s48, 0
spin_3:
    ds_read_b32 v12, v11
    s_add_u32 s48, s48, 1
    s_waitcnt lgkmcnt(0)
    v_readfirstlane_b32 s47, v12
    s_cmp_ge_u32 s48, 262144
    s_cbranch_scc1 spin_3_x
    s_cmp_lt_u32 s47, 1
    s_cbranch_scc1 spin_3
spin_3_x:
    v_mov_b32 v11, 162580
    s_mov_b32 s48, 0
spin_4:
    ds_read_b32 v12, v11
    s_add_u32 s48, s48, 1
    s_waitcnt lgkmcnt(0)
    v_readfirstlane_b32 s47, v12
    s_cmp_ge_u32 s48, 262144
    s_cbranch_scc1 spin_4_x
    s_cmp_lt_u32 s47, 4
    s_cbranch_scc1 spin_4
spin_4_x:
    buffer_load_dwordx4 v[16:19], v2, s[16:19], s32 offen sc1
    buffer_load_dwordx4 v[20:23], v3, s[16:19], s32 offen sc1
    buffer_load_dwordx4 v[24:27], v4, s[16:19], s32 offen sc1
    buffer_load_dwordx4 v[28:31], v5, s[16:19], s32 offen sc1
    s_add_u32 s32, s32, 4096
    buffer_load_dwordx4 v[32:35], v2, s[16:19], s32 offen sc1
    buffer_load_dwordx4 v[36:39], v3, s[16:19], s32 offen sc1
    buffer_load_dwordx4 v[40:43], v4, s[16:19], s32 offen sc1
    buffer_load_dwordx4 v[44:47], v5, s[16:19], s32 offen sc1
    s_add_u32 s32, s32, 4096
    buffer_load_dwordx4 v[48:51], v2, s[16:19], s32 offen sc1
    buffer_load_dwordx4 v[52:55], v3, s[16:19], s32 offen sc1
    buffer_load_dwordx4 v[56:59], v4, s[16:19], s32 offen sc1
    buffer_load_dwordx4 v[60:63], v5, s[16:19], s32 offen sc1
    s_add_u32 s32, s32, 4096
    buffer_load_dwordx4 v[64:67], v2, s[16:19], s32 offen sc1
    buffer_load_dwordx4 v[68:71], v3, s[16:19], s32 offen sc1
    buffer_load_dwordx4 v[72:75], v4, s[16:19], s32 offen sc1
    buffer_load_dwordx4 v[76:79], v5, s[16:19], s32 offen sc1
    s_add_u32 s32, s32, 4096
    s_waitcnt vmcnt(12)
    v_mfma_f32_16x16x32_bf16 v[176:179], v[96:99], v[16:19], 0
    v_mfma_f32_16x16x32_bf16 v[196:199], v[96:99], v[20:23], 0
    buffer_load_dwordx4 v[80:83], v2, s[16:19], s32 offen sc1
    v_mfma_f32_16x16x32_bf16 v[216:219], v[96:99], v[24:27], 0
    v_mfma_f32_16x16x32_bf16 v[236:239], v[96:99], v[28:31], 0
    ds_read_b128 v[96:99], v15 offset:0
    v_mfma_f32_16x16x32_bf16 v[180:183], v[100:103], v[16:19], 0
    v_mfma_f32_16x16x32_bf16 v[200:203], v[100:103], v[20:23], 0
    buffer_load_dwordx4 v[84:87], v3, s[16:19], s32 offen sc1
    v_mfma_f32_16x16x32_bf16 v[220:223], v[100:103], v[24:27], 0
    v_mfma_f32_16x16x32_bf16 v[240:243], v[100:103], v[28:31], 0
    ds_read_b128 v[100:103], v15 offset:1024
    v_mfma_f32_16x16x32_bf16 v[184:187], v[104:107], v[16:19], 0
    v_mfma_f32_16x16x32_bf16 v[204:207], v[104:107], v[20:23], 0
    buffer_load_dwordx4 v[88:91], v4, s[16:19], s32 offen sc1
    v_mfma_f32_16x16x32_bf16 v[224:227], v[104:107], v[24:27], 0
    v_mfma_f32_16x16x32_bf16 v[244:247], v[104:107], v[28:31], 0
    ds_read_b128 v[104:107], v15 offset:2048
    v_mfma_f32_16x16x32_bf16 v[188:191], v[108:111], v[16:19], 0
    v_mfma_f32_16x16x32_bf16 v[208:211], v[108:111], v[20:23], 0
    buffer_load_dwordx4 v[92:95], v5, s[16:19], s32 offen sc1
    s_add_u32 s32, s32, 4096
    v_mfma_f32_16x16x32_bf16 v[228:231], v[108:111], v[24:27], 0
    v_mfma_f32_16x16x32_bf16 v[248:251], v[108:111], v[28:31], 0
    ds_read_b128 v[108:111], v15 offset:3072
    v_mfma_f32_16x16x32_bf16 v[192:195], v[112:115], v[16:19], 0
    v_mfma_f32_16x16x32_bf16 v[212:215], v[112:115], v[20:23], 0
    v_mfma_f32_16x16x32_bf16 v[232:235], v[112:115], v[24:27], 0
    v_mfma_f32_16x16x32_bf16 v[252:255], v[112:115], v[28:31], 0
    ds_read_b128 v[112:115], v15 offset:4096
    s_waitcnt vmcnt(12)
    v_mfma_f32_16x16x32_bf16 v[176:179], v[116:119], v[32:35], v[176:179]
    v_mfma_f32_16x16x32_bf16 v[196:199], v[116:119], v[36:39], v[196:199]
    buffer_load_dwordx4 v[16:19], v2, s[16:19], s32 offen sc1
    v_mfma_f32_16x16x32_bf16 v[216:219], v[116:119], v[40:43], v[216:219]
    v_mfma_f32_16x16x32_bf16 v[236:239], v[116:119], v[44:47], v[236:239]
    ds_read_b128 v[116:119], v15 offset:20480
    v_mfma_f32_16x16x32_bf16 v[180:183], v[120:123], v[32:35], v[180:183]
    v_mfma_f32_16x16x32_bf16 v[200:203], v[120:123], v[36:39], v[200:203]
    buffer_load_dwordx4 v[20:23], v3, s[16:19], s32 offen sc1
    v_mfma_f32_16x16x32_bf16 v[220:223], v[120:123], v[40:43], v[220:223]
    v_mfma_f32_16x16x32_bf16 v[240:243], v[120:123], v[44:47], v[240:243]
    ds_read_b128 v[120:123], v15 offset:21504
    v_mfma_f32_16x16x32_bf16 v[184:187], v[124:127], v[32:35], v[184:187]
    v_mfma_f32_16x16x32_bf16 v[204:207], v[124:127], v[36:39], v[204:207]
    buffer_load_dwordx4 v[24:27], v4, s[16:19], s32 offen sc1
    v_mfma_f32_16x16x32_bf16 v[224:227], v[124:127], v[40:43], v[224:227]
    v_mfma_f32_16x16x32_bf16 v[244:247], v[124:127], v[44:47], v[244:247]
    ds_read_b128 v[124:127], v15 offset:22528
    v_mfma_f32_16x16x32_bf16 v[188:191], v[128:131], v[32:35], v[188:191]
    v_mfma_f32_16x16x32_bf16 v[208:211], v[128:131], v[36:39], v[208:211]
    buffer_load_dwordx4 v[28:31], v5, s[16:19], s32 offen sc1
    s_add_u32 s32, s32, 4096
    v_mfma_f32_16x16x32_bf16 v[228:231], v[128:131], v[40:43], v[228:231]
    v_mfma_f32_16x16x32_bf16 v[248:251], v[128:131], v[44:47], v[248:251]
    ds_read_b128 v[128:131], v15 offset:23552
    v_mfma_f32_16x16x32_bf16 v[192:195], v[132:135], v[32:35], v[192:195]
    v_mfma_f32_16x16x32_bf16 v[212:215], v[132:135], v[36:39], v[212:215]
    v_mfma_f32_16x16x32_bf16 v[232:235], v[132:135], v[40:43], v[232:235]
    v_mfma_f32_16x16x32_bf16 v[252:255], v[132:135], v[44:47], v[252:255]
    ds_read_b128 v[132:135], v15 offset:24576
    v_and_b32 v12, 7, v14
    v_lshlrev_b32 v12, 7, v12
    buffer_load_dword v12, v12, s[16:19], s54 offen sc1
    s_waitcnt vmcnt(13)
    v_mfma_f32_16x16x32_bf16 v[176:179], v[136:139], v[48:51], v[176:179]
    v_mfma_f32_16x16x32_bf16 v[196:199], v[136:139], v[52:55], v[196:199]
    buffer_load_dwordx4 v[32:35], v2, s[16:19], s32 offen sc1
    v_mfma_f32_16x16x32_bf16 v[216:219], v[136:139], v[56:59], v[216:219]
    v_mfma_f32_16x16x32_bf16 v[236:239], v[136:139], v[60:63], v[236:239]
    ds_read_b128 v[136:139], v1 offset:0
    v_mfma_f32_16x16x32_bf16 v[180:183], v[140:143], v[48:51], v[180:183]
    v_mfma_f32_16x16x32_bf16 v[200:203], v[140:143], v[52:55], v[200:203]
    buffer_load_dwordx4 v[36:39], v3, s[16:19], s32 offen sc1
    v_mfma_f32_16x16x32_bf16 v[220:223], v[140:143], v[56:59], v[220:223]
    v_mfma_f32_16x16x32_bf16 v[240:243], v[140:143], v[60:63], v[240:243]
    ds_read_b128 v[140:143], v1 offset:1024
    v_mfma_f32_16x16x32_bf16 v[184:187], v[144:147], v[48:51], v[184:187]
    v_mfma_f32_16x16x32_bf16 v[204:207], v[144:147], v[52:55], v[204:207]
    buffer_load_dwordx4 v[40:43], v4, s[16:19], s32 offen sc1
    v_mfma_f32_16x16x32_bf16 v[224:227], v[144:147], v[56:59], v[224:227]
    v_mfma_f32_16x16x32_bf16 v[244:247], v[144:147], v[60:63], v[244:247]
    ds_read_b128 v[144:147], v1 offset:2048
    v_mfma_f32_16x16x32_bf16 v[188:191], v[148:151], v[48:51], v[188:191]
    v_mfma_f32_16x16x32_bf16 v[208:211], v[148:151], v[52:55], v[208:211]
    buffer_load_dwordx4 v[44:47], v5, s[16:19], s32 offen sc1
    s_add_u32 s32, s32, 4096
    v_mfma_f32_16x16x32_bf16 v[228:231], v[148:151], v[56:59], v[228:231]
    v_mfma_f32_16x16x32_bf16 v[248:251], v[148:151], v[60:63], v[248:251]
    ds_read_b128 v[148:151], v1 offset:3072
    v_mfma_f32_16x16x32_bf16 v[192:195], v[152:155], v[48:51], v[192:195]
    v_mfma_f32_16x16x32_bf16 v[212:215], v[152:155], v[52:55], v[212:215]
    v_mfma_f32_16x16x32_bf16 v[232:235], v[152:155], v[56:59], v[232:235]
    v_mfma_f32_16x16x32_bf16 v[252:255], v[152:155], v[60:63], v[252:255]
    ds_read_b128 v[152:155], v1 offset:4096
    s_waitcnt vmcnt(13)
    v_mfma_f32_16x16x32_bf16 v[176:179], v[156:159], v[64:67], v[176:179]
    v_mfma_f32_16x16x32_bf16 v[196:199], v[156:159], v[68:71], v[196:199]
    buffer_load_dwordx4 v[48:51], v2, s[16:19], s32 offen sc1
    v_mfma_f32_16x16x32_bf16 v[216:219], v[156:159], v[72:75], v[216:219]
    v_mfma_f32_16x16x32_bf16 v[236:239], v[156:159], v[76:79], v[236:239]
    ds_read_b128 v[156:159], v1 offset:20480
    v_mfma_f32_16x16x32_bf16 v[180:183], v[160:163], v[64:67], v[180:183]
    v_mfma_f32_16x16x32_bf16 v[200:203], v[160:163], v[68:71], v[200:203]
    buffer_load_dwordx4 v[52:55], v3, s[16:19], s32 offen sc1
    v_mfma_f32_16x16x32_bf16 v[220:223], v[160:163], v[72:75], v[220:223]
    v_mfma_f32_16x16x32_bf16 v[240:243], v[160:163], v[76:79], v[240:243]
    ds_read_b128 v[160:163], v1 offset:21504
    v_mfma_f32_16x16x32_bf16 v[184:187], v[164:167], v[64:67], v[184:187]
    v_mfma_f32_16x16x32_bf16 v[204:207], v[164:167], v[68:71], v[204:207]
    buffer_load_dwordx4 v[56:59], v4, s[16:19], s32 offen sc1
    v_mfma_f32_16x16x32_bf16 v[224:227], v[164:167], v[72:75], v[224:227]
    v_mfma_f32_16x16x32_bf16 v[244:247], v[164:167], v[76:79], v[244:247]
    ds_read_b128 v[164:167], v1 offset:22528
    v_mfma_f32_16x16x32_bf16 v[188:191], v[168:171], v[64:67], v[188:191]
    v_mfma_f32_16x16x32_bf16 v[208:211], v[168:171], v[68:71], v[208:211]
    buffer_load_dwordx4 v[60:63], v5, s[16:19], s32 offen sc1
    s_add_u32 s32, s32, 4096
    v_mfma_f32_16x16x32_bf16 v[228:231], v[168:171], v[72:75], v[228:231]
    v_mfma_f32_16x16x32_bf16 v[248:251], v[168:171], v[76:79], v[248:251]
    ds_read_b128 v[168:171], v1 offset:23552
    v_mfma_f32_16x16x32_bf16 v[192:195], v[172:175], v[64:67], v[192:195]
    v_mfma_f32_16x16x32_bf16 v[212:215], v[172:175], v[68:71], v[212:215]
    v_mfma_f32_16x16x32_bf16 v[232:235], v[172:175], v[72:75], v[232:235]
    v_mfma_f32_16x16x32_bf16 v[252:255], v[172:175], v[76:79], v[252:255]
    ds_read_b128 v[172:175], v1 offset:24576
    s_waitcnt vmcnt(8)
    v_cmp_eq_u32 vcc, s53, v12
    s_cmp_eq_u64 vcc, -1
    s_cbranch_scc1 F_fa0
    v_lshlrev_b32 v10, 7, v14
    s_mov_b32 s48, 0
    s_mov_b64 exec, s[40:41]
poll_5:
    buffer_load_dword v11, v10, s[16:19], s54 offen sc1
    s_add_u32 s48, s48, 1
    s_waitcnt vmcnt(0)
    v_cmp_eq_u32 vcc, s53, v11
    s_cmp_ge_u32 s48, 262144
    s_cbranch_scc1 poll_5_x
    s_cmp_eq_u64 vcc, s[40:41]
    s_cbranch_scc0 poll_5
poll_5_x:
    s_mov_b64 exec, -1
F_fa0:
    s_waitcnt vmcnt(13) lgkmcnt(15)
    v_mfma_f32_16x16x32_bf16 v[176:179], v[96:99], v[80:83], v[176:179]
    v_mfma_f32_16x16x32_bf16 v[196:199], v[96:99], v[84:87], v[196:199]
    buffer_load_dwordx4 v[64:67], v2, s[16:19], s32 offen sc1
    v_mfma_f32_16x16x32_bf16 v[216:219], v[96:99], v[88:91], v[216:219]
    v_mfma_f32_16x16x32_bf16 v[236:239], v[96:99], v[92:95], v[236:239]
    buffer_load_dwordx4 v[96:99], v6, s[16:19], s33 offen offset:0 sc1
    v_mfma_f32_16x16x32_bf16 v[180:183], v[100:103], v[80:83], v[180:183]
    v_mfma_f32_16x16x32_bf16 v[200:203], v[100:103], v[84:87], v[200:203]
    buffer_load_dwordx4 v[68:71], v3, s[16:19], s32 offen sc1
    v_mfma_f32_16x16x32_bf16 v[220:223], v[100:103], v[88:91], v[220:223]
    v_mfma_f32_16x16x32_bf16 v[240:243], v[100:103], v[92:95], v[240:243]
    buffer_load_dwordx4 v[100:103], v6, s[16:19], s33 offen offset:1024 sc1
    v_mfma_f32_16x16x32_bf16 v[184:187], v[104:107], v[80:83], v[184:187]
    v_mfma_f32_16x16x32_bf16 v[204:207], v[104:107], v[84:87], v[204:207]
    buffer_load_dwordx4 v[72:75], v4, s[16:19], s32 offen sc1
    v_mfma_f32_16x16x32_bf16 v[224:227], v[104:107], v[88:91], v[224:227]
    v_mfma_f32_16x16x32_bf16 v[244:247], v[104:107], v[92:95], v[244:247]
    buffer_load_dwordx4 v[104:107], v6, s[16:19], s33 offen offset:2048 sc1
    v_mfma_f32_16x16x32_bf16 v[188:191], v[108:111], v[80:83], v[188:191]
    v_mfma_f32_16x16x32_bf16 v[208:211], v[108:111], v[84:87], v[208:211]
    buffer_load_dwordx4 v[76:79], v5, s[16:19], s32 offen sc1
    s_add_u32 s32, s32, 4096
    v_mfma_f32_16x16x32_bf16 v[228:231], v[108:111], v[88:91], v[228:231]
    v_mfma_f32_16x16x32_bf16 v[248:251], v[108:111], v[92:95], v[248:251]
    buffer_load_dwordx4 v[108:111], v6, s[16:19], s33 offen offset:3072 sc1
    v_mfma_f32_16x16x32_bf16 v[192:195], v[112:115], v[80:83], v[192:195]
    v_mfma_f32_16x16x32_bf16 v[212:215], v[112:115], v[84:87], v[212:215]
    v_mfma_f32_16x16x32_bf16 v[232:235], v[112:115], v[88:91], v[232:235]
    v_mfma_f32_16x16x32_bf16 v[252:255], v[112:115], v[92:95], v[252:255]
    buffer_load_dwordx4 v[112:115], v7, s[16:19], s33 offen offset:0 sc1
    s_add_u32 s33, s33, 20480
    s_waitcnt vmcnt(18) lgkmcnt(10)
    v_mfma_f32_16x16x32_bf16 v[176:179], v[116:119], v[16:19], v[176:179]
    v_mfma_f32_16x16x32_bf16 v[196:199], v[116:119], v[20:23], v[196:199]
    buffer_load_dwordx4 v[80:83], v2, s[16:19], s32 offen sc1
    v_mfma_f32_16x16x32_bf16 v[216:219], v[116:119], v[24:27], v[216:219]
    v_mfma_f32_16x16x32_bf16 v[236:239], v[116:119], v[28:31], v[236:239]
    buffer_load_dwordx4 v[116:119], v6, s[16:19], s33 offen offset:0 sc1
    v_mfma_f32_16x16x32_bf16 v[180:183], v[120:123], v[16:19], v[180:183]
    v_mfma_f32_16x16x32_bf16 v[200:203], v[120:123], v[20:23], v[200:203]
    buffer_load_dwordx4 v[84:87], v3, s[16:19], s32 offen sc1
    v_mfma_f32_16x16x32_bf16 v[220:223], v[120:123], v[24:27], v[220:223]
    v_mfma_f32_16x16x32_bf16 v[240:243], v[120:123], v[28:31], v[240:243]
    buffer_load_dwordx4 v[120:123], v6, s[16:19], s33 offen offset:1024 sc1
    v_mfma_f32_16x16x32_bf16 v[184:187], v[124:127], v[16:19], v[184:187]
    v_mfma_f32_16x16x32_bf16 v[204:207], v[124:127], v[20:23], v[204:207]
    buffer_load_dwordx4 v[88:91], v4, s[16:19], s32 offen sc1
    v_mfma_f32_16x16x32_bf16 v[224:227], v[124:127], v[24:27], v[224:227]
    v_mfma_f32_16x16x32_bf16 v[244:247], v[124:127], v[28:31], v[244:247]
    buffer_load_dwordx4 v[124:127], v6, s[16:19], s33 offen offset:2048 sc1
    v_mfma_f32_16x16x32_bf16 v[188:191], v[128:131], v[16:19], v[188:191]
    v_mfma_f32_16x16x32_bf16 v[208:211], v[128:131], v[20:23], v[208:211]
    buffer_load_dwordx4 v[92:95], v5, s[16:19], s32 offen sc1
    s_add_u32 s32, s32, 4096
    v_mfma_f32_16x16x32_bf16 v[228:231], v[128:131], v[24:27], v[228:231]
    v_mfma_f32_16x16x32_bf16 v[248:251], v[128:131], v[28:31], v[248:251]
    buffer_load_dwordx4 v[128:131], v6, s[16:19], s33 offen offset:3072 sc1
    v_mfma_f32_16x16x32_bf16 v[192:195], v[132:135], v[16:19], v[192:195]
    v_mfma_f32_16x16x32_bf16 v[212:215], v[132:135], v[20:23], v[212:215]
    v_mfma_f32_16x16x32_bf16 v[232:235], v[132:135], v[24:27], v[232:235]
    v_mfma_f32_16x16x32_bf16 v[252:255], v[132:135], v[28:31], v[252:255]
    buffer_load_dwordx4 v[132:135], v7, s[16:19], s33 offen offset:0 sc1
    s_add_u32 s33, s33, 20480
    s_waitcnt vmcnt(22) lgkmcnt(5)
    v_mfma_f32_16x16x32_bf16 v[176:179], v[136:139], v[32:35], v[176:179]
    v_mfma_f32_16x16x32_bf16 v[196:199], v[136:139], v[36:39], v[196:199]
    buffer_load_dwordx4 v[16:19], v2, s[16:19], s32 offen sc1
    v_mfma_f32_16x16x32_bf16 v[216:219], v[136:139], v[40:43], v[216:219]
    v_mfma_f32_16x16x32_bf16 v[236:239], v[136:139], v[44:47], v[236:239]
    buffer_load_dwordx4 v[136:139], v6, s[16:19], s33 offen offset:0 sc1
    v_mfma_f32_16x16x32_bf16 v[180:183], v[140:143], v[32:35], v[180:183]
    v_mfma_f32_16x16x32_bf16 v[200:203], v[140:143], v[36:39], v[200:203]
    buffer_load_dwordx4 v[20:23], v3, s[16:19], s32 offen sc1
    v_mfma_f32_16x16x32_bf16 v[220:223], v[140:143], v[40:43], v[220:223]
    v_mfma_f32_16x16x32_bf16 v[240:243], v[140:143], v[44:47], v[240:243]
    buffer_load_dwordx4 v[140:143], v6, s[16:19], s33 offen offset:1024 sc1
    v_mfma_f32_16x16x32_bf16 v[184:187], v[144:147], v[32:35], v[184:187]
    v_mfma_f32_16x16x32_bf16 v[204:207], v[144:147], v[36:39], v[204:207]
    buffer_load_dwordx4 v[24:27], v4, s[16:19], s32 offen sc1
    v_mfma_f32_16x16x32_bf16 v[224:227], v[144:147], v[40:43], v[224:227]
    v_mfma_f32_16x16x32_bf16 v[244:247], v[144:147], v[44:47], v[244:247]
    buffer_load_dwordx4 v[144:147], v6, s[16:19], s33 offen offset:2048 sc1
    v_mfma_f32_16x16x32_bf16 v[188:191], v[148:151], v[32:35], v[188:191]
    v_mfma_f32_16x16x32_bf16 v[208:211], v[148:151], v[36:39], v[208:211]
    buffer_load_dwordx4 v[28:31], v5, s[16:19], s32 offen sc1
    s_add_u32 s32, s32, 4096
    v_mfma_f32_16x16x32_bf16 v[228:231], v[148:151], v[40:43], v[228:231]
    v_mfma_f32_16x16x32_bf16 v[248:251], v[148:151], v[44:47], v[248:251]
    buffer_load_dwordx4 v[148:151], v6, s[16:19], s33 offen offset:3072 sc1
    v_mfma_f32_16x16x32_bf16 v[192:195], v[152:155], v[32:35], v[192:195]
    v_mfma_f32_16x16x32_bf16 v[212:215], v[152:155], v[36:39], v[212:215]
    v_mfma_f32_16x16x32_bf16 v[232:235], v[152:155], v[40:43], v[232:235]
    v_mfma_f32_16x16x32_bf16 v[252:255], v[152:155], v[44:47], v[252:255]
    buffer_load_dwordx4 v[152:155], v7, s[16:19], s33 offen offset:0 sc1
    s_add_u32 s33, s33, 20480
    s_waitcnt vmcnt(27) lgkmcnt(0)
    v_mfma_f32_16x16x32_bf16 v[176:179], v[156:159], v[48:51], v[176:179]
    v_mfma_f32_16x16x32_bf16 v[196:199], v[156:159], v[52:55], v[196:199]
    buffer_load_dwordx4 v[32:35], v2, s[16:19], s32 offen sc1
    v_mfma_f32_16x16x32_bf16 v[216:219], v[156:159], v[56:59], v[216:219]
    v_mfma_f32_16x16x32_bf16 v[236:239], v[156:159], v[60:63], v[236:239]
    buffer_load_dwordx4 v[156:159], v6, s[16:19], s33 offen offset:0 sc1
    v_mfma_f32_16x16x32_bf16 v[180:183], v[160:163], v[48:51], v[180:183]
    v_mfma_f32_16x16x32_bf16 v[200:203], v[160:163], v[52:55], v[200:203]
    buffer_load_dwordx4 v[36:39], v3, s[16:19], s32 offen sc1
    v_mfma_f32_16x16x32_bf16 v[220:223], v[160:163], v[56:59], v[220:223]
    v_mfma_f32_16x16x32_bf16 v[240:243], v[160:163], v[60:63], v[240:243]
    buffer_load_dwordx4 v[160:163], v6, s[16:19], s33 offen offset:1024 sc1
    v_mfma_f32_16x16x32_bf16 v[184:187], v[164:167], v[48:51], v[184:187]
    v_mfma_f32_16x16x32_bf16 v[204:207], v[164:167], v[52:55], v[204:207]
    buffer_load_dwordx4 v[40:43], v4, s[16:19], s32 offen sc1
    v_mfma_f32_16x16x32_bf16 v[224:227], v[164:167], v[56:59], v[224:227]
    v_mfma_f32_16x16x32_bf16 v[244:247], v[164:167], v[60:63], v[244:247]
    buffer_load_dwordx4 v[164:167], v6, s[16:19], s33 offen offset:2048 sc1
    v_mfma_f32_16x16x32_bf16 v[188:191], v[168:171], v[48:51], v[188:191]
    v_mfma_f32_16x16x32_bf16 v[208:211], v[168:171], v[52:55], v[208:211]
    buffer_load_dwordx4 v[44:47], v5, s[16:19], s32 offen sc1
    s_add_u32 s32, s32, s57
    v_mfma_f32_16x16x32_bf16 v[228:231], v[168:171], v[56:59], v[228:231]
    v_mfma_f32_16x16x32_bf16 v[248:251], v[168:171], v[60:63], v[248:251]
    buffer_load_dwordx4 v[168:171], v6, s[16:19], s33 offen offset:3072 sc1
    v_mfma_f32_16x16x32_bf16 v[192:195], v[172:175], v[48:51], v[192:195]
    v_mfma_f32_16x16x32_bf16 v[212:215], v[172:175], v[52:55], v[212:215]
    v_mfma_f32_16x16x32_bf16 v[232:235], v[172:175], v[56:59], v[232:235]
    v_mfma_f32_16x16x32_bf16 v[252:255], v[172:175], v[60:63], v[252:255]
    buffer_load_dwordx4 v[172:175], v7, s[16:19], s33 offen offset:0 sc1
    s_add_u32 s33, s33, s58
    s_mov_b32 s52, s33
    s_add_u32 s33, s33, 20480
    s_add_u32 m0, s37, 133120
    s_nop 0
    buffer_load_dwordx4 v6, s[16:19], s33 offen offset:0 sc1 lds
    buffer_load_dwordx4 v6, s[16:19], s33 offen offset:1024 sc1 lds
    buffer_load_dwordx4 v6, s[16:19], s33 offen offset:2048 sc1 lds
    buffer_load_dwordx4 v6, s[16:19], s33 offen offset:3072 sc1 lds
    s_add_u32 m0, s37, 137216
    s_nop 0
    buffer_load_dwordx4 v7, s[16:19], s33 offen sc1 lds
    s_add_u32 s33, s33, 20480
    s_mov_b32 s33, s52
    s_waitcnt vmcnt(32)
    v_mfma_f32_16x16x32_bf16 v[176:179], v[96:99], v[64:67], v[176:179]
    v_mfma_f32_16x16x32_bf16 v[196:199], v[96:99], v[68:71], v[196:199]
    v_mfma_f32_16x16x32_bf16 v[216:219], v[96:99], v[72:75], v[216:219]
    v_mfma_f32_16x16x32_bf16 v[236:239], v[96:99], v[76:79], v[236:239]
    buffer_load_dwordx4 v[96:99], v6, s[16:19], s33 offen offset:0 sc1
    v_mfma_f32_16x16x32_bf16 v[180:183], v[100:103], v[64:67], v[180:183]
    v_mfma_f32_16x16x32_bf16 v[200:203], v[100:103], v[68:71], v[200:203]
    v_mfma_f32_16x16x32_bf16 v[220:223], v[100:103], v[72:75], v[220:223]
    v_mfma_f32_16x16x32_bf16 v[240:243], v[100:103], v[76:79], v[240:243]
    buffer_load_dwordx4 v[100:103], v6, s[16:19], s33 offen offset:1024 sc1
    v_mfma_f32_16x16x32_bf16 v[184:187], v[104:107], v[64:67], v[184:187]
    v_mfma_f32_16x16x32_bf16 v[204:207], v[104:107], v[68:71], v[204:207]
    v_mfma_f32_16x16x32_bf16 v[224:227], v[104:107], v[72:75], v[224:227]
    v_mfma_f32_16x16x32_bf16 v[244:247], v[104:107], v[76:79], v[244:247]
    buffer_load_dwordx4 v[104:107], v6, s[16:19], s33 offen offset:2048 sc1
    v_mfma_f32_16x16x32_bf16 v[188:191], v[108:111], v[64:67], v[188:191]
    v_mfma_f32_16x16x32_bf16 v[208:211], v[108:111], v[68:71], v[208:211]
    v_mfma_f32_16x16x32_bf16 v[228:231], v[108:111], v[72:75], v[228:231]
    v_mfma_f32_16x16x32_bf16 v[248:251], v[108:111], v[76:79], v[248:251]
    buffer_load_dwordx4 v[108:111], v6, s[16:19], s33 offen offset:3072 sc1
    v_mfma_f32_16x16x32_bf16 v[192:195], v[112:115], v[64:67], v[192:195]
    v_mfma_f32_16x16x32_bf16 v[212:215], v[112:115], v[68:71], v[212:215]
    v_mfma_f32_16x16x32_bf16 v[232:235], v[112:115], v[72:75], v[232:235]
    v_mfma_f32_16x16x32_bf16 v[252:255], v[112:115], v[76:79], v[252:255]
    buffer_load_dwordx4 v[112:115], v7, s[16:19], s33 offen offset:0 sc1
    s_add_u32 s33, s33, 5120
    buffer_load_dwordx4 v[48:51], v8, s[4:7], s34 offen offset:0
    buffer_load_dwordx4 v[52:55], v8, s[4:7], s34 offen offset:16
    buffer_load_dwordx2 v[56:57], v8, s[4:7], s34 offen offset:32
    buffer_load_dwordx4 v[58:61], v9, s[72:75], s35 offen offset:0
    buffer_load_dwordx4 v[62:65], v9, s[72:75], s35 offen offset:16
    buffer_load_dwordx2 v[66:67], v9, s[72:75], s35 offen offset:32
    s_waitcnt vmcnt(34)
    v_mfma_f32_16x16x32_bf16 v[176:179], v[116:119], v[80:83], v[176:179]
    v_mfma_f32_16x16x32_bf16 v[196:199], v[116:119], v[84:87], v[196:199]
    v_mfma_f32_16x16x32_bf16 v[216:219], v[116:119], v[88:91], v[216:219]
    v_mfma_f32_16x16x32_bf16 v[236:239], v[116:119], v[92:95], v[236:239]
    buffer_load_dwordx4 v[116:119], v6, s[16:19], s33 offen offset:0 sc1
    v_mfma_f32_16x16x32_bf16 v[180:183], v[120:123], v[80:83], v[180:183]
    v_mfma_f32_16x16x32_bf16 v[200:203], v[120:123], v[84:87], v[200:203]
    v_mfma_f32_16x16x32_bf16 v[220:223], v[120:123], v[88:91], v[220:223]
    v_mfma_f32_16x16x32_bf16 v[240:243], v[120:123], v[92:95], v[240:243]
    buffer_load_dwordx4 v[120:123], v6, s[16:19], s33 offen offset:1024 sc1
    v_mfma_f32_16x16x32_bf16 v[184:187], v[124:127], v[80:83], v[184:187]
    v_mfma_f32_16x16x32_bf16 v[204:207], v[124:127], v[84:87], v[204:207]
    v_mfma_f32_16x16x32_bf16 v[224:227], v[124:127], v[88:91], v[224:227]
    v_mfma_f32_16x16x32_bf16 v[244:247], v[124:127], v[92:95], v[244:247]
    buffer_load_dwordx4 v[124:127], v6, s[16:19], s33 offen offset:2048 sc1
    v_mfma_f32_16x16x32_bf16 v[188:191], v[128:131], v[80:83], v[188:191]
    v_mfma_f32_16x16x32_bf16 v[208:211], v[128:131], v[84:87], v[208:211]
    v_mfma_f32_16x16x32_bf16 v[228:231], v[128:131], v[88:91], v[228:231]
    v_mfma_f32_16x16x32_bf16 v[248:251], v[128:131], v[92:95], v[248:251]
    buffer_load_dwordx4 v[128:131], v6, s[16:19], s33 offen offset:3072 sc1
    v_mfma_f32_16x16x32_bf16 v[192:195], v[132:135], v[80:83], v[192:195]
    v_mfma_f32_16x16x32_bf16 v[212:215], v[132:135], v[84:87], v[212:215]
    v_mfma_f32_16x16x32_bf16 v[232:235], v[132:135], v[88:91], v[232:235]
    v_mfma_f32_16x16x32_bf16 v[252:255], v[132:135], v[92:95], v[252:255]
    buffer_load_dwordx4 v[132:135], v7, s[16:19], s33 offen offset:0 sc1
    s_add_u32 s33, s33, 5120
    s_waitcnt vmcnt(30)
    v_mfma_f32_16x16x32_bf16 v[176:179], v[136:139], v[16:19], v[176:179]
    v_mfma_f32_16x16x32_bf16 v[196:199], v[136:139], v[20:23], v[196:199]
    v_mfma_f32_16x16x32_bf16 v[216:219], v[136:139], v[24:27], v[216:219]
    v_mfma_f32_16x16x32_bf16 v[236:239], v[136:139], v[28:31], v[236:239]
    buffer_load_dwordx4 v[136:139], v6, s[16:19], s33 offen offset:0 sc1
    v_mfma_f32_16x16x32_bf16 v[180:183], v[140:143], v[16:19], v[180:183]
    v_mfma_f32_16x16x32_bf16 v[200:203], v[140:143], v[20:23], v[200:203]
    v_mfma_f32_16x16x32_bf16 v[220:223], v[140:143], v[24:27], v[220:223]
    v_mfma_f32_16x16x32_bf16 v[240:243], v[140:143], v[28:31], v[240:243]
    buffer_load_dwordx4 v[140:143], v6, s[16:19], s33 offen offset:1024 sc1
    v_mfma_f32_16x16x32_bf16 v[184:187], v[144:147], v[16:19], v[184:187]
    v_mfma_f32_16x16x32_bf16 v[204:207], v[144:147], v[20:23], v[204:207]
    v_mfma_f32_16x16x32_bf16 v[224:227], v[144:147], v[24:27], v[224:227]
    v_mfma_f32_16x16x32_bf16 v[244:247], v[144:147], v[28:31], v[244:247]
    buffer_load_dwordx4 v[144:147], v6, s[16:19], s33 offen offset:2048 sc1
    v_mfma_f32_16x16x32_bf16 v[188:191], v[148:151], v[16:19], v[188:191]
    v_mfma_f32_16x16x32_bf16 v[208:211], v[148:151], v[20:23], v[208:211]
    v_mfma_f32_16x16x32_bf16 v[228:231], v[148:151], v[24:27], v[228:231]
    v_mfma_f32_16x16x32_bf16 v[248:251], v[148:151], v[28:31], v[248:251]
    buffer_load_dwordx4 v[148:151], v6, s[16:19], s33 offen offset:3072 sc1
    v_mfma_f32_16x16x32_bf16 v[192:195], v[152:155], v[16:19], v[192:195]
    v_mfma_f32_16x16x32_bf16 v[212:215], v[152:155], v[20:23], v[212:215]
    v_mfma_f32_16x16x32_bf16 v[232:235], v[152:155], v[24:27], v[232:235]
    v_mfma_f32_16x16x32_bf16 v[252:255], v[152:155], v[28:31], v[252:255]
    buffer_load_dwordx4 v[152:155], v7, s[16:19], s33 offen offset:0 sc1
    s_add_u32 s33, s33, 5120
    s_waitcnt vmcnt(26)
    v_mfma_f32_16x16x32_bf16 v[176:179], v[156:159], v[32:35], v[176:179]
    v_mfma_f32_16x16x32_bf16 v[196:199], v[156:159], v[36:39], v[196:199]
    v_mfma_f32_16x16x32_bf16 v[216:219], v[156:159], v[40:43], v[216:219]
    v_mfma_f32_16x16x32_bf16 v[236:239], v[156:159], v[44:47], v[236:239]
    buffer_load_dwordx4 v[156:159], v6, s[16:19], s33 offen offset:0 sc1
    v_mfma_f32_16x16x32_bf16 v[180:183], v[160:163], v[32:35], v[180:183]
    v_mfma_f32_16x16x32_bf16 v[200:203], v[160:163], v[36:39], v[200:203]
    v_mfma_f32_16x16x32_bf16 v[220:223], v[160:163], v[40:43], v[220:223]
    v_mfma_f32_16x16x32_bf16 v[240:243], v[160:163], v[44:47], v[240:243]
    buffer_load_dwordx4 v[160:163], v6, s[16:19], s33 offen offset:1024 sc1
    v_mfma_f32_16x16x32_bf16 v[184:187], v[164:167], v[32:35], v[184:187]
    v_mfma_f32_16x16x32_bf16 v[204:207], v[164:167], v[36:39], v[204:207]
    v_mfma_f32_16x16x32_bf16 v[224:227], v[164:167], v[40:43], v[224:227]
    v_mfma_f32_16x16x32_bf16 v[244:247], v[164:167], v[44:47], v[244:247]
    buffer_load_dwordx4 v[164:167], v6, s[16:19], s33 offen offset:2048 sc1
    v_mfma_f32_16x16x32_bf16 v[188:191], v[168:171], v[32:35], v[188:191]
    v_mfma_f32_16x16x32_bf16 v[208:211], v[168:171], v[36:39], v[208:211]
    v_mfma_f32_16x16x32_bf16 v[228:231], v[168:171], v[40:43], v[228:231]
    v_mfma_f32_16x16x32_bf16 v[248:251], v[168:171], v[44:47], v[248:251]
    buffer_load_dwordx4 v[168:171], v6, s[16:19], s33 offen offset:3072 sc1
    v_mfma_f32_16x16x32_bf16 v[192:195], v[172:175], v[32:35], v[192:195]
    v_mfma_f32_16x16x32_bf16 v[212:215], v[172:175], v[36:39], v[212:215]
    v_mfma_f32_16x16x32_bf16 v[232:235], v[172:175], v[40:43], v[232:235]
    v_mfma_f32_16x16x32_bf16 v[252:255], v[172:175], v[44:47], v[252:255]
    buffer_load_dwordx4 v[172:175], v7, s[16:19], s33 offen offset:0 sc1
    s_add_u32 s33, s33, 5120
    v_and_b32 v0, 1, v14
    v_lshlrev_b32 v0, 7, v0
    buffer_load_dword v0, v0, s[16:19], s55 offen sc1
    s_waitcnt vmcnt(16)
    s_mov_b32 s39, 0xffff0000
    v_lshlrev_b32 v68, 16, v48
    v_and_b32 v69, s39, v48
    v_lshlrev_b32 v70, 16, v58
    v_and_b32 v71, s39, v58
    v_pk_add_f32 v[68:69], v[68:69], v[70:71]
    v_pk_add_f32 v[176:177], v[176:177], v[68:69]
    v_lshlrev_b32 v68, 16, v49
    v_and_b32 v69, s39, v49
    v_lshlrev_b32 v70, 16, v59
    v_and_b32 v71, s39, v59
    v_pk_add_f32 v[68:69], v[68:69], v[70:71]
    v_pk_add_f32 v[178:179], v[178:179], v[68:69]
    v_lshlrev_b32 v68, 16, v50
    v_and_b32 v69, s39, v50
    v_lshlrev_b32 v70, 16, v60
    v_and_b32 v71, s39, v60
    v_pk_add_f32 v[68:69], v[68:69], v[70:71]
    v_pk_add_f32 v[180:181], v[180:181], v[68:69]
    v_lshlrev_b32 v68, 16, v51
    v_and_b32 v69, s39, v51
    v_lshlrev_b32 v70, 16, v61
    v_and_b32 v71, s39, v61
    v_pk_add_f32 v[68:69], v[68:69], v[70:71]
    v_pk_add_f32 v[182:183], v[182:183], v[68:69]
    v_lshlrev_b32 v68, 16, v52
    v_and_b32 v69, s39, v52
    v_lshlrev_b32 v70, 16, v62
    v_and_b32 v71, s39, v62
    v_pk_add_f32 v[68:69], v[68:69], v[70:71]
    v_pk_add_f32 v[184:185], v[184:185], v[68:69]
    v_lshlrev_b32 v68, 16, v53
    v_and_b32 v69, s39, v53
    v_lshlrev_b32 v70, 16, v63
    v_and_b32 v71, s39, v63
    v_pk_add_f32 v[68:69], v[68:69], v[70:71]
    v_pk_add_f32 v[186:187], v[186:187], v[68:69]
    v_lshlrev_b32 v68, 16, v54
    v_and_b32 v69, s39, v54
    v_lshlrev_b32 v70, 16, v64
    v_and_b32 v71, s39, v64
    v_pk_add_f32 v[68:69], v[68:69], v[70:71]
    v_pk_add_f32 v[188:189], v[188:189], v[68:69]
    v_lshlrev_b32 v68, 16, v55
    v_and_b32 v69, s39, v55
    v_lshlrev_b32 v70, 16, v65
    v_and_b32 v71, s39, v65
    v_pk_add_f32 v[68:69], v[68:69], v[70:71]
    v_pk_add_f32 v[190:191], v[190:191], v[68:69]
    v_lshlrev_b32 v68, 16, v56
    v_and_b32 v69, s39, v56
    v_lshlrev_b32 v70, 16, v66
    v_and_b32 v71, s39, v66
    v_pk_add_f32 v[68:69], v[68:69], v[70:71]
    v_pk_add_f32 v[192:193], v[192:193], v[68:69]
    v_lshlrev_b32 v68, 16, v57
    v_and_b32 v69, s39, v57
    v_lshlrev_b32 v70, 16, v67
    v_and_b32 v71, s39, v67
    v_pk_add_f32 v[68:69], v[68:69], v[70:71]
    v_pk_add_f32 v[194:195], v[194:195], v[68:69]
    v_mov_b32 v11, 162580
    s_mov_b32 s48, 0
spin_6:
    ds_read_b32 v12, v11
    s_add_u32 s48, s48, 1
    s_waitcnt lgkmcnt(0)
    v_readfirstlane_b32 s47, v12
    s_cmp_ge_u32 s48, 262144
    s_cbranch_scc1 spin_6_x
    s_cmp_lt_u32 s47, 4
    s_cbranch_scc1 spin_6
spin_6_x:
    s_waitcnt vmcnt(0)
    v_cmp_eq_u32 vcc, s53, v0
    s_cmp_eq_u64 vcc, -1
    s_cbranch_scc1 F_fo0
    v_lshlrev_b32 v10, 7, v14
    s_mov_b32 s48, 0
    s_mov_b64 exec, 3
poll_7:
    buffer_load_dword v11, v10, s[16:19], s55 offen sc1
    s_add_u32 s48, s48, 1
    s_waitcnt vmcnt(0)
    v_cmp_eq_u32 vcc, s53, v11
    s_cmp_ge_u32 s48, 262144
    s_cbranch_scc1 poll_7_x
    s_cmp_eq_u64 vcc, 3
    s_cbranch_scc0 poll_7
poll_7_x:
    s_mov_b64 exec, -1
F_fo0:
    s_mov_b32 s56, s32
    buffer_load_dwordx4 v[48:51], v2, s[16:19], s32 offen sc1
    buffer_load_dwordx4 v[52:55], v3, s[16:19], s32 offen sc1
    buffer_load_dwordx4 v[56:59], v4, s[16:19], s32 offen sc1
    buffer_load_dwordx4 v[60:63], v5, s[16:19], s32 offen sc1
    s_add_u32 s32, s32, 1024
    buffer_load_dwordx4 v[64:67], v2, s[16:19], s32 offen sc1
    buffer_load_dwordx4 v[68:71], v3, s[16:19], s32 offen sc1
    buffer_load_dwordx4 v[72:75], v4, s[16:19], s32 offen sc1
    buffer_load_dwordx4 v[76:79], v5, s[16:19], s32 offen sc1
    s_add_u32 s32, s32, 1024
    buffer_load_dwordx4 v[80:83], v2, s[16:19], s32 offen sc1
    buffer_load_dwordx4 v[84:87], v3, s[16:19], s32 offen sc1
    buffer_load_dwordx4 v[88:91], v4, s[16:19], s32 offen sc1
    buffer_load_dwordx4 v[92:95], v5, s[16:19], s32 offen sc1
    s_add_u32 s32, s32, 1024
    buffer_load_dwordx4 v[16:19], v2, s[16:19], s32 offen sc1
    buffer_load_dwordx4 v[20:23], v3, s[16:19], s32 offen sc1
    buffer_load_dwordx4 v[24:27], v4, s[16:19], s32 offen sc1
    buffer_load_dwordx4 v[28:31], v5, s[16:19], s32 offen sc1
    s_add_u32 s32, s32, 1024
    buffer_load_dwordx4 v[32:35], v2, s[16:19], s32 offen sc1
    buffer_load_dwordx4 v[36:39], v3, s[16:19], s32 offen sc1
    buffer_load_dwordx4 v[40:43], v4, s[16:19], s32 offen sc1
    buffer_load_dwordx4 v[44:47], v5, s[16:19], s32 offen sc1
    s_add_u32 s32, s32, 1024
    s_mov_b32 s48, 0
    s_sub_u32 s36, s31, 1
    s_and_b32 s36, s36, 3
    s_mul_i32 s36, s36, 5120
    v_add_u32 v10, s36, v6
    s_sub_u32 s36, s31, 2
    s_and_b32 s36, s36, 3
    s_mul_i32 s36, s36, 5120
    v_add_u32 v11, s36, v6
    s_sub_u32 s36, s31, 3
    s_and_b32 s36, s36, 3
    s_mul_i32 s36, s36, 5120
    v_add_u32 v12, s36, v6
    s_waitcnt vmcnt(16)
    v_mfma_f32_16x16x32_bf16 v[176:179], v[96:99], v[48:51], v[176:179]
    v_mfma_f32_16x16x32_bf16 v[196:199], v[96:99], v[52:55], v[196:199]
    v_mfma_f32_16x16x32_bf16 v[216:219], v[96:99], v[56:59], v[216:219]
    v_mfma_f32_16x16x32_bf16 v[236:239], v[96:99], v[60:63], v[236:239]
    ds_read_b128 v[96:99], v1 offset:20480
    v_mfma_f32_16x16x32_bf16 v[180:183], v[100:103], v[48:51], v[180:183]
    v_mfma_f32_16x16x32_bf16 v[200:203], v[100:103], v[52:55], v[200:203]
    v_mfma_f32_16x16x32_bf16 v[220:223], v[100:103], v[56:59], v[220:223]
    v_mfma_f32_16x16x32_bf16 v[240:243], v[100:103], v[60:63], v[240:243]
    ds_read_b128 v[100:103], v1 offset:21504
    v_mfma_f32_16x16x32_bf16 v[184:187], v[104:107], v[48:51], v[184:187]
    v_mfma_f32_16x16x32_bf16 v[204:207], v[104:107], v[52:55], v[204:207]
    v_mfma_f32_16x16x32_bf16 v[224:227], v[104:107], v[56:59], v[224:227]
    v_mfma_f32_16x16x32_bf16 v[244:247], v[104:107], v[60:63], v[244:247]
    ds_read_b128 v[104:107], v1 offset:22528
    v_mfma_f32_16x16x32_bf16 v[188:191], v[108:111], v[48:51], v[188:191]
    v_mfma_f32_16x16x32_bf16 v[208:211], v[108:111], v[52:55], v[208:211]
    v_mfma_f32_16x16x32_bf16 v[228:231], v[108:111], v[56:59], v[228:231]
    v_mfma_f32_16x16x32_bf16 v[248:251], v[108:111], v[60:63], v[248:251]
    ds_read_b128 v[108:111], v1 offset:23552
    v_mfma_f32_16x16x32_bf16 v[192:195], v[112:115], v[48:51], v[192:195]
    v_mfma_f32_16x16x32_bf16 v[212:215], v[112:115], v[52:55], v[212:215]
    v_mfma_f32_16x16x32_bf16 v[232:235], v[112:115], v[56:59], v[232:235]
    v_mfma_f32_16x16x32_bf16 v[252:255], v[112:115], v[60:63], v[252:255]
    ds_read_b128 v[112:115], v1 offset:24576
    s_waitcnt vmcnt(12)
    v_mfma_f32_16x16x32_bf16 v[176:179], v[116:119], v[64:67], v[176:179]
    v_mfma_f32_16x16x32_bf16 v[196:199], v[116:119], v[68:71], v[196:199]
    v_mfma_f32_16x16x32_bf16 v[216:219], v[116:119], v[72:75], v[216:219]
    v_mfma_f32_16x16x32_bf16 v[236:239], v[116:119], v[76:79], v[236:239]
    v_mfma_f32_16x16x32_bf16 v[180:183], v[120:123], v[64:67], v[180:183]
    v_mfma_f32_16x16x32_bf16 v[200:203], v[120:123], v[68:71], v[200:203]
    v_mfma_f32_16x16x32_bf16 v[220:223], v[120:123], v[72:75], v[220:223]
    v_mfma_f32_16x16x32_bf16 v[240:243], v[120:123], v[76:79], v[240:243]
    v_mfma_f32_16x16x32_bf16 v[184:187], v[124:127], v[64:67], v[184:187]
    v_mfma_f32_16x16x32_bf16 v[204:207], v[124:127], v[68:71], v[204:207]
    v_mfma_f32_16x16x32_bf16 v[224:227], v[124:127], v[72:75], v[224:227]
    v_mfma_f32_16x16x32_bf16 v[244:247], v[124:127], v[76:79], v[244:247]
    v_mfma_f32_16x16x32_bf16 v[188:191], v[128:131], v[64:67], v[188:191]
    v_mfma_f32_16x16x32_bf16 v[208:211], v[128:131], v[68:71], v[208:211]
    v_mfma_f32_16x16x32_bf16 v[228:231], v[128:131], v[72:75], v[228:231]
    v_mfma_f32_16x16x32_bf16 v[248:251], v[128:131], v[76:79], v[248:251]
    v_mfma_f32_16x16x32_bf16 v[192:195], v[132:135], v[64:67], v[192:195]
    v_mfma_f32_16x16x32_bf16 v[212:215], v[132:135], v[68:71], v[212:215]
    v_mfma_f32_16x16x32_bf16 v[232:235], v[132:135], v[72:75], v[232:235]
    v_mfma_f32_16x16x32_bf16 v[252:255], v[132:135], v[76:79], v[252:255]
    s_waitcnt vmcnt(8)
    v_mfma_f32_16x16x32_bf16 v[176:179], v[136:139], v[80:83], v[176:179]
    v_mfma_f32_16x16x32_bf16 v[196:199], v[136:139], v[84:87], v[196:199]
    v_mfma_f32_16x16x32_bf16 v[216:219], v[136:139], v[88:91], v[216:219]
    v_mfma_f32_16x16x32_bf16 v[236:239], v[136:139], v[92:95], v[236:239]
    v_mfma_f32_16x16x32_bf16 v[180:183], v[140:143], v[80:83], v[180:183]
    v_mfma_f32_16x16x32_bf16 v[200:203], v[140:143], v[84:87], v[200:203]
    v_mfma_f32_16x16x32_bf16 v[220:223], v[140:143], v[88:91], v[220:223]
    v_mfma_f32_16x16x32_bf16 v[240:243], v[140:143], v[92:95], v[240:243]
    v_mfma_f32_16x16x32_bf16 v[184:187], v[144:147], v[80:83], v[184:187]
    v_mfma_f32_16x16x32_bf16 v[204:207], v[144:147], v[84:87], v[204:207]
    v_mfma_f32_16x16x32_bf16 v[224:227], v[144:147], v[88:91], v[224:227]
    v_mfma_f32_16x16x32_bf16 v[244:247], v[144:147], v[92:95], v[244:247]
    v_mfma_f32_16x16x32_bf16 v[188:191], v[148:151], v[80:83], v[188:191]
    v_mfma_f32_16x16x32_bf16 v[208:211], v[148:151], v[84:87], v[208:211]
    v_mfma_f32_16x16x32_bf16 v[228:231], v[148:151], v[88:91], v[228:231]
    v_mfma_f32_16x16x32_bf16 v[248:251], v[148:151], v[92:95], v[248:251]
    v_mfma_f32_16x16x32_bf16 v[192:195], v[152:155], v[80:83], v[192:195]
    v_mfma_f32_16x16x32_bf16 v[212:215], v[152:155], v[84:87], v[212:215]
    v_mfma_f32_16x16x32_bf16 v[232:235], v[152:155], v[88:91], v[232:235]
    v_mfma_f32_16x16x32_bf16 v[252:255], v[152:155], v[92:95], v[252:255]
    s_waitcnt vmcnt(4)
    v_mfma_f32_16x16x32_bf16 v[176:179], v[156:159], v[16:19], v[176:179]
    v_mfma_f32_16x16x32_bf16 v[196:199], v[156:159], v[20:23], v[196:199]
    v_mfma_f32_16x16x32_bf16 v[216:219], v[156:159], v[24:27], v[216:219]
    v_mfma_f32_16x16x32_bf16 v[236:239], v[156:159], v[28:31], v[236:239]
    v_mfma_f32_16x16x32_bf16 v[180:183], v[160:163], v[16:19], v[180:183]
    v_mfma_f32_16x16x32_bf16 v[200:203], v[160:163], v[20:23], v[200:203]
    v_mfma_f32_16x16x32_bf16 v[220:223], v[160:163], v[24:27], v[220:223]
    v_mfma_f32_16x16x32_bf16 v[240:243], v[160:163], v[28:31], v[240:243]
    v_mfma_f32_16x16x32_bf16 v[184:187], v[164:167], v[16:19], v[184:187]
    v_mfma_f32_16x16x32_bf16 v[204:207], v[164:167], v[20:23], v[204:207]
    v_mfma_f32_16x16x32_bf16 v[224:227], v[164:167], v[24:27], v[224:227]
    v_mfma_f32_16x16x32_bf16 v[244:247], v[164:167], v[28:31], v[244:247]
    v_mfma_f32_16x16x32_bf16 v[188:191], v[168:171], v[16:19], v[188:191]
    v_mfma_f32_16x16x32_bf16 v[208:211], v[168:171], v[20:23], v[208:211]
    v_mfma_f32_16x16x32_bf16 v[228:231], v[168:171], v[24:27], v[228:231]
    v_mfma_f32_16x16x32_bf16 v[248:251], v[168:171], v[28:31], v[248:251]
    v_mfma_f32_16x16x32_bf16 v[192:195], v[172:175], v[16:19], v[192:195]
    v_mfma_f32_16x16x32_bf16 v[212:215], v[172:175], v[20:23], v[212:215]
    v_mfma_f32_16x16x32_bf16 v[232:235], v[172:175], v[24:27], v[232:235]
    v_mfma_f32_16x16x32_bf16 v[252:255], v[172:175], v[28:31], v[252:255]
    s_waitcnt vmcnt(0) lgkmcnt(0)
    v_mfma_f32_16x16x32_bf16 v[196:199], v[96:99], v[36:39], v[196:199]
    v_mfma_f32_16x16x32_bf16 v[200:203], v[100:103], v[36:39], v[200:203]
    v_mfma_f32_16x16x32_bf16 v[204:207], v[104:107], v[36:39], v[204:207]
    v_mfma_f32_16x16x32_bf16 v[208:211], v[108:111], v[36:39], v[208:211]
    v_mfma_f32_16x16x32_bf16 v[212:215], v[112:115], v[36:39], v[212:215]
    v_mfma_f32_16x16x32_bf16 v[216:219], v[96:99], v[40:43], v[216:219]
    s_nop 2
    ds_write_b128 v15, v[196:199] offset:0
    v_mfma_f32_16x16x32_bf16 v[220:223], v[100:103], v[40:43], v[220:223]
    ds_write_b128 v15, v[200:203] offset:1024
    v_mfma_f32_16x16x32_bf16 v[224:227], v[104:107], v[40:43], v[224:227]
    ds_write_b128 v15, v[204:207] offset:2048
    v_mfma_f32_16x16x32_bf16 v[228:231], v[108:111], v[40:43], v[228:231]
    ds_write_b128 v15, v[208:211] offset:3072
    v_mfma_f32_16x16x32_bf16 v[232:235], v[112:115], v[40:43], v[232:235]
    ds_write_b128 v15, v[212:215] offset:4096
    v_mfma_f32_16x16x32_bf16 v[236:239], v[96:99], v[44:47], v[236:239]
    ds_write_b128 v15, v[216:219] offset:20480
    v_mfma_f32_16x16x32_bf16 v[240:243], v[100:103], v[44:47], v[240:243]
    ds_write_b128 v15, v[220:223] offset:21504
    v_mfma_f32_16x16x32_bf16 v[244:247], v[104:107], v[44:47], v[244:247]
    ds_write_b128 v15, v[224:227] offset:22528
    v_mfma_f32_16x16x32_bf16 v[248:251], v[108:111], v[44:47], v[248:251]
    ds_write_b128 v15, v[228:231] offset:23552
    v_mfma_f32_16x16x32_bf16 v[252:255], v[112:115], v[44:47], v[252:255]
    ds_write_b128 v15, v[232:235] offset:24576
    v_mfma_f32_16x16x32_bf16 v[176:179], v[96:99], v[32:35], v[176:179]
    ds_write_b128 v15, v[236:239] offset:40960
    v_mfma_f32_16x16x32_bf16 v[180:183], v[100:103], v[32:35], v[180:183]
    ds_write_b128 v15, v[240:243] offset:41984
    v_mfma_f32_16x16x32_bf16 v[184:187], v[104:107], v[32:35], v[184:187]
    ds_write_b128 v15, v[244:247] offset:43008
    v_mfma_f32_16x16x32_bf16 v[188:191], v[108:111], v[32:35], v[188:191]
    ds_write_b128 v15, v[248:251] offset:44032
    v_mfma_f32_16x16x32_bf16 v[192:195], v[112:115], v[32:35], v[192:195]
    ds_write_b128 v15, v[252:255] offset:45056
    s_branch F_p2_e
F_p2_1:
    s_add_u32 m0, s37, 40960
    s_nop 0
    buffer_load_dwordx4 v6, s[16:19], s33 offen offset:0 sc1 lds
    buffer_load_dwordx4 v6, s[16:19], s33 offen offset:1024 sc1 lds
    buffer_load_dwordx4 v6, s[16:19], s33 offen offset:2048 sc1 lds
    buffer_load_dwordx4 v6, s[16:19], s33 offen offset:3072 sc1 lds
    s_add_u32 m0, s37, 45056
    s_nop 0
    buffer_load_dwordx4 v7, s[16:19], s33 offen sc1 lds
    s_add_u32 s33, s33, 20480
    s_add_u32 m0, s37, 61440
    s_nop 0
    buffer_load_dwordx4 v6, s[16:19], s33 offen offset:0 sc1 lds
    buffer_load_dwordx4 v6, s[16:19], s33 offen offset:1024 sc1 lds
    buffer_load_dwordx4 v6, s[16:19], s33 offen offset:2048 sc1 lds
    buffer_load_dwordx4 v6, s[16:19], s33 offen offset:3072 sc1 lds
    s_add_u32 m0, s37, 65536
    s_nop 0
    buffer_load_dwordx4 v7, s[16:19], s33 offen sc1 lds
    s_add_u32 s33, s33, 20480
    s_add_u32 m0, s37, 81920
    s_nop 0
    buffer_load_dwordx4 v6, s[16:19], s33 offen offset:0 sc1 lds
    buffer_load_dwordx4 v6, s[16:19], s33 offen offset:1024 sc1 lds
    buffer_load_dwordx4 v6, s[16:19], s33 offen offset:2048 sc1 lds
    buffer_load_dwordx4 v6, s[16:19], s33 offen offset:3072 sc1 lds
    s_add_u32 m0, s37, 86016
    s_nop 0
    buffer_load_dwordx4 v7, s[16:19], s33 offen sc1 lds
    s_add_u32 s33, s33, 20480
    s_add_u32 m0, s37, 102400
    s_nop 0
    buffer_load_dwordx4 v6, s[16:19], s33 offen offset:0 sc1 lds
    buffer_load_dwordx4 v6, s[16:19], s33 offen offset:1024 sc1 lds
    buffer_load_dwordx4 v6, s[16:19], s33 offen offset:2048 sc1 lds
    buffer_load_dwordx4 v6, s[16:19], s33 offen offset:3072 sc1 lds
    s_add_u32 m0, s37, 106496
    s_nop 0
    buffer_load_dwordx4 v7, s[16:19], s33 offen sc1 lds
    s_add_u32 s33, s33, 20480
    s_add_u32 m0, s37, 122880
    s_nop 0
    buffer_load_dwordx4 v6, s[16:19], s33 offen offset:0 sc1 lds
    buffer_load_dwordx4 v6, s[16:19], s33 offen offset:1024 sc1 lds
    buffer_load_dwordx4 v6, s[16:19], s33 offen offset:2048 sc1 lds
    buffer_load_dwordx4 v6, s[16:19], s33 offen offset:3072 sc1 lds
    s_add_u32 m0, s37, 126976
    s_nop 0
    buffer_load_dwordx4 v7, s[16:19], s33 offen sc1 lds
    s_add_u32 s33, s33, 20480
    s_lshr_b32 s54, s28, 1
    s_lshl_b32 s54, s54, 11
    s_add_u32 s54, s54, 2097152
    s_mov_b64 s[38:39], 0xff00
    s_mov_b64 s[40:41], 0xff
    s_cmp_eq_u32 s31, 0
    s_cbranch_scc0 F_p2_wait1
    v_lshlrev_b32 v10, 7, v14
    s_mov_b32 s48, 0
    s_mov_b64 exec, s[38:39]
poll_8:
    buffer_load_dword v11, v10, s[16:19], s54 offen sc1
    s_add_u32 s48, s48, 1
    s_waitcnt vmcnt(0)
    v_cmp_eq_u32 vcc, s53, v11
    s_cmp_ge_u32 s48, 262144
    s_cbranch_scc1 poll_8_x
    s_cmp_eq_u64 vcc, s[38:39]
    s_cbranch_scc0 poll_8
poll_8_x:
    s_mov_b64 exec, -1
    v_mov_b32 v10, 1
    v_mov_b32 v11, 162584
    ds_write_b32 v11, v10
    s_waitcnt lgkmcnt(0)
F_p2_wait1:
    v_mov_b32 v11, 162584
    s_mov_b32 s48, 0
spin_9:
    ds_read_b32 v12, v11
    s_add_u32 s48, s48, 1
    s_waitcnt lgkmcnt(0)
    v_readfirstlane_b32 s47, v12
    s_cmp_ge_u32 s48, 262144
    s_cbranch_scc1 spin_9_x
    s_cmp_lt_u32 s47, 1
    s_cbranch_scc1 spin_9
spin_9_x:
    buffer_load_dwordx4 v[16:19], v2, s[16:19], s32 offen sc1
    buffer_load_dwordx4 v[20:23], v3, s[16:19], s32 offen sc1
    buffer_load_dwordx4 v[24:27], v4, s[16:19], s32 offen sc1
    buffer_load_dwordx4 v[28:31], v5, s[16:19], s32 offen sc1
    s_add_u32 s32, s32, 4096
    buffer_load_dwordx4 v[32:35], v2, s[16:19], s32 offen sc1
    buffer_load_dwordx4 v[36:39], v3, s[16:19], s32 offen sc1
    buffer_load_dwordx4 v[40:43], v4, s[16:19], s32 offen sc1
    buffer_load_dwordx4 v[44:47], v5, s[16:19], s32 offen sc1
    s_add_u32 s32, s32, 4096
    buffer_load_dwordx4 v[48:51], v2, s[16:19], s32 offen sc1
    buffer_load_dwordx4 v[52:55], v3, s[16:19], s32 offen sc1
    buffer_load_dwordx4 v[56:59], v4, s[16:19], s32 offen sc1
    buffer_load_dwordx4 v[60:63], v5, s[16:19], s32 offen sc1
    s_add_u32 s32, s32, 4096
    buffer_load_dwordx4 v[64:67], v2, s[16:19], s32 offen sc1
    buffer_load_dwordx4 v[68:71], v3, s[16:19], s32 offen sc1
    buffer_load_dwordx4 v[72:75], v4, s[16:19], s32 offen sc1
    buffer_load_dwordx4 v[76:79], v5, s[16:19], s32 offen sc1
    s_add_u32 s32, s32, 4096
    s_waitcnt vmcnt(12)
    v_mfma_f32_16x16x32_bf16 v[176:179], v[96:99], v[16:19], 0
    v_mfma_f32_16x16x32_bf16 v[196:199], v[96:99], v[20:23], 0
    buffer_load_dwordx4 v[80:83], v2, s[16:19], s32 offen sc1
    v_mfma_f32_16x16x32_bf16 v[216:219], v[96:99], v[24:27], 0
    v_mfma_f32_16x16x32_bf16 v[236:239], v[96:99], v[28:31], 0
    ds_read_b128 v[96:99], v15 offset:0
    v_mfma_f32_16x16x32_bf16 v[180:183], v[100:103], v[16:19], 0
    v_mfma_f32_16x16x32_bf16 v[200:203], v[100:103], v[20:23], 0
    buffer_load_dwordx4 v[84:87], v3, s[16:19], s32 offen sc1
    v_mfma_f32_16x16x32_bf16 v[220:223], v[100:103], v[24:27], 0
    v_mfma_f32_16x16x32_bf16 v[240:243], v[100:103], v[28:31], 0
    ds_read_b128 v[100:103], v15 offset:1024
    v_mfma_f32_16x16x32_bf16 v[184:187], v[104:107], v[16:19], 0
    v_mfma_f32_16x16x32_bf16 v[204:207], v[104:107], v[20:23], 0
    buffer_load_dwordx4 v[88:91], v4, s[16:19], s32 offen sc1
    v_mfma_f32_16x16x32_bf16 v[224:227], v[104:107], v[24:27], 0
    v_mfma_f32_16x16x32_bf16 v[244:247], v[104:107], v[28:31], 0
    ds_read_b128 v[104:107], v15 offset:2048
    v_mfma_f32_16x16x32_bf16 v[188:191], v[108:111], v[16:19], 0
    v_mfma_f32_16x16x32_bf16 v[208:211], v[108:111], v[20:23], 0
    buffer_load_dwordx4 v[92:95], v5, s[16:19], s32 offen sc1
    s_add_u32 s32, s32, 4096
    v_mfma_f32_16x16x32_bf16 v[228:231], v[108:111], v[24:27], 0
    v_mfma_f32_16x16x32_bf16 v[248:251], v[108:111], v[28:31], 0
    ds_read_b128 v[108:111], v15 offset:3072
    v_mfma_f32_16x16x32_bf16 v[192:195], v[112:115], v[16:19], 0
    v_mfma_f32_16x16x32_bf16 v[212:215], v[112:115], v[20:23], 0
    v_mfma_f32_16x16x32_bf16 v[232:235], v[112:115], v[24:27], 0
    v_mfma_f32_16x16x32_bf16 v[252:255], v[112:115], v[28:31], 0
    ds_read_b128 v[112:115], v15 offset:4096
    s_waitcnt vmcnt(12)
    v_mfma_f32_16x16x32_bf16 v[176:179], v[116:119], v[32:35], v[176:179]
    v_mfma_f32_16x16x32_bf16 v[196:199], v[116:119], v[36:39], v[196:199]
    buffer_load_dwordx4 v[16:19], v2, s[16:19], s32 offen sc1
    v_mfma_f32_16x16x32_bf16 v[216:219], v[116:119], v[40:43], v[216:219]
    v_mfma_f32_16x16x32_bf16 v[236:239], v[116:119], v[44:47], v[236:239]
    ds_read_b128 v[116:119], v15 offset:20480
    v_mfma_f32_16x16x32_bf16 v[180:183], v[120:123], v[32:35], v[180:183]
    v_mfma_f32_16x16x32_bf16 v[200:203], v[120:123], v[36:39], v[200:203]
    buffer_load_dwordx4 v[20:23], v3, s[16:19], s32 offen sc1
    v_mfma_f32_16x16x32_bf16 v[220:223], v[120:123], v[40:43], v[220:223]
    v_mfma_f32_16x16x32_bf16 v[240:243], v[120:123], v[44:47], v[240:243]
    ds_read_b128 v[120:123], v15 offset:21504
    v_mfma_f32_16x16x32_bf16 v[184:187], v[124:127], v[32:35], v[184:187]
    v_mfma_f32_16x16x32_bf16 v[204:207], v[124:127], v[36:39], v[204:207]
    buffer_load_dwordx4 v[24:27], v4, s[16:19], s32 offen sc1
    v_mfma_f32_16x16x32_bf16 v[224:227], v[124:127], v[40:43], v[224:227]
    v_mfma_f32_16x16x32_bf16 v[244:247], v[124:127], v[44:47], v[244:247]
    ds_read_b128 v[124:127], v15 offset:22528
    v_mfma_f32_16x16x32_bf16 v[188:191], v[128:131], v[32:35], v[188:191]
    v_mfma_f32_16x16x32_bf16 v[208:211], v[128:131], v[36:39], v[208:211]
    buffer_load_dwordx4 v[28:31], v5, s[16:19], s32 offen sc1
    s_add_u32 s32, s32, 4096
    v_mfma_f32_16x16x32_bf16 v[228:231], v[128:131], v[40:43], v[228:231]
    v_mfma_f32_16x16x32_bf16 v[248:251], v[128:131], v[44:47], v[248:251]
    ds_read_b128 v[128:131], v15 offset:23552
    v_mfma_f32_16x16x32_bf16 v[192:195], v[132:135], v[32:35], v[192:195]
    v_mfma_f32_16x16x32_bf16 v[212:215], v[132:135], v[36:39], v[212:215]
    v_mfma_f32_16x16x32_bf16 v[232:235], v[132:135], v[40:43], v[232:235]
    v_mfma_f32_16x16x32_bf16 v[252:255], v[132:135], v[44:47], v[252:255]
    ds_read_b128 v[132:135], v15 offset:24576
    v_and_b32 v12, 7, v14
    v_lshlrev_b32 v12, 7, v12
    buffer_load_dword v12, v12, s[16:19], s54 offen sc1
    s_waitcnt vmcnt(13)
    v_mfma_f32_16x16x32_bf16 v[176:179], v[136:139], v[48:51], v[176:179]
    v_mfma_f32_16x16x32_bf16 v[196:199], v[136:139], v[52:55], v[196:199]
    buffer_load_dwordx4 v[32:35], v2, s[16:19], s32 offen sc1
    v_mfma_f32_16x16x32_bf16 v[216:219], v[136:139], v[56:59], v[216:219]
    v_mfma_f32_16x16x32_bf16 v[236:239], v[136:139], v[60:63], v[236:239]
    ds_read_b128 v[136:139], v15 offset:40960
    v_mfma_f32_16x16x32_bf16 v[180:183], v[140:143], v[48:51], v[180:183]
    v_mfma_f32_16x16x32_bf16 v[200:203], v[140:143], v[52:55], v[200:203]
    buffer_load_dwordx4 v[36:39], v3, s[16:19], s32 offen sc1
    v_mfma_f32_16x16x32_bf16 v[220:223], v[140:143], v[56:59], v[220:223]
    v_mfma_f32_16x16x32_bf16 v[240:243], v[140:143], v[60:63], v[240:243]
    ds_read_b128 v[140:143], v15 offset:41984
    v_mfma_f32_16x16x32_bf16 v[184:187], v[144:147], v[48:51], v[184:187]
    v_mfma_f32_16x16x32_bf16 v[204:207], v[144:147], v[52:55], v[204:207]
    buffer_load_dwordx4 v[40:43], v4, s[16:19], s32 offen sc1
    v_mfma_f32_16x16x32_bf16 v[224:227], v[144:147], v[56:59], v[224:227]
    v_mfma_f32_16x16x32_bf16 v[244:247], v[144:147], v[60:63], v[244:247]
    ds_read_b128 v[144:147], v15 offset:43008
    v_mfma_f32_16x16x32_bf16 v[188:191], v[148:151], v[48:51], v[188:191]
    v_mfma_f32_16x16x32_bf16 v[208:211], v[148:151], v[52:55], v[208:211]
    buffer_load_dwordx4 v[44:47], v5, s[16:19], s32 offen sc1
    s_add_u32 s32, s32, 4096
    v_mfma_f32_16x16x32_bf16 v[228:231], v[148:151], v[56:59], v[228:231]
    v_mfma_f32_16x16x32_bf16 v[248:251], v[148:151], v[60:63], v[248:251]
    ds_read_b128 v[148:151], v15 offset:44032
    v_mfma_f32_16x16x32_bf16 v[192:195], v[152:155], v[48:51], v[192:195]
    v_mfma_f32_16x16x32_bf16 v[212:215], v[152:155], v[52:55], v[212:215]
    v_mfma_f32_16x16x32_bf16 v[232:235], v[152:155], v[56:59], v[232:235]
    v_mfma_f32_16x16x32_bf16 v[252:255], v[152:155], v[60:63], v[252:255]
    ds_read_b128 v[152:155], v15 offset:45056
    s_waitcnt vmcnt(13)
    v_mfma_f32_16x16x32_bf16 v[176:179], v[156:159], v[64:67], v[176:179]
    v_mfma_f32_16x16x32_bf16 v[196:199], v[156:159], v[68:71], v[196:199]
    buffer_load_dwordx4 v[48:51], v2, s[16:19], s32 offen sc1
    v_mfma_f32_16x16x32_bf16 v[216:219], v[156:159], v[72:75], v[216:219]
    v_mfma_f32_16x16x32_bf16 v[236:239], v[156:159], v[76:79], v[236:239]
    ds_read_b128 v[156:159], v13 offset:0
    v_mfma_f32_16x16x32_bf16 v[180:183], v[160:163], v[64:67], v[180:183]
    v_mfma_f32_16x16x32_bf16 v[200:203], v[160:163], v[68:71], v[200:203]
    buffer_load_dwordx4 v[52:55], v3, s[16:19], s32 offen sc1
    v_mfma_f32_16x16x32_bf16 v[220:223], v[160:163], v[72:75], v[220:223]
    v_mfma_f32_16x16x32_bf16 v[240:243], v[160:163], v[76:79], v[240:243]
    ds_read_b128 v[160:163], v13 offset:1024
    v_mfma_f32_16x16x32_bf16 v[184:187], v[164:167], v[64:67], v[184:187]
    v_mfma_f32_16x16x32_bf16 v[204:207], v[164:167], v[68:71], v[204:207]
    buffer_load_dwordx4 v[56:59], v4, s[16:19], s32 offen sc1
    v_mfma_f32_16x16x32_bf16 v[224:227], v[164:167], v[72:75], v[224:227]
    v_mfma_f32_16x16x32_bf16 v[244:247], v[164:167], v[76:79], v[244:247]
    ds_read_b128 v[164:167], v13 offset:2048
    v_mfma_f32_16x16x32_bf16 v[188:191], v[168:171], v[64:67], v[188:191]
    v_mfma_f32_16x16x32_bf16 v[208:211], v[168:171], v[68:71], v[208:211]
    buffer_load_dwordx4 v[60:63], v5, s[16:19], s32 offen sc1
    s_add_u32 s32, s32, 4096
    v_mfma_f32_16x16x32_bf16 v[228:231], v[168:171], v[72:75], v[228:231]
    v_mfma_f32_16x16x32_bf16 v[248:251], v[168:171], v[76:79], v[248:251]
    ds_read_b128 v[168:171], v13 offset:3072
    v_mfma_f32_16x16x32_bf16 v[192:195], v[172:175], v[64:67], v[192:195]
    v_mfma_f32_16x16x32_bf16 v[212:215], v[172:175], v[68:71], v[212:215]
    v_mfma_f32_16x16x32_bf16 v[232:235], v[172:175], v[72:75], v[232:235]
    v_mfma_f32_16x16x32_bf16 v[252:255], v[172:175], v[76:79], v[252:255]
    ds_read_b128 v[172:175], v13 offset:4096
    s_waitcnt vmcnt(8)
    v_cmp_eq_u32 vcc, s53, v12
    s_cmp_eq_u64 vcc, -1
    s_cbranch_scc1 F_fa1
    v_lshlrev_b32 v10, 7, v14
    s_mov_b32 s48, 0
    s_mov_b64 exec, s[40:41]
poll_10:
    buffer_load_dword v11, v10, s[16:19], s54 offen sc1
    s_add_u32 s48, s48, 1
    s_waitcnt vmcnt(0)
    v_cmp_eq_u32 vcc, s53, v11
    s_cmp_ge_u32 s48, 262144
    s_cbranch_scc1 poll_10_x
    s_cmp_eq_u64 vcc, s[40:41]
    s_cbranch_scc0 poll_10
poll_10_x:
    s_mov_b64 exec, -1
F_fa1:
    s_waitcnt vmcnt(13) lgkmcnt(15)
    v_mfma_f32_16x16x32_bf16 v[176:179], v[96:99], v[80:83], v[176:179]
    v_mfma_f32_16x16x32_bf16 v[196:199], v[96:99], v[84:87], v[196:199]
    buffer_load_dwordx4 v[64:67], v2, s[16:19], s32 offen sc1
    v_mfma_f32_16x16x32_bf16 v[216:219], v[96:99], v[88:91], v[216:219]
    v_mfma_f32_16x16x32_bf16 v[236:239], v[96:99], v[92:95], v[236:239]
    ds_read_b128 v[96:99], v13 offset:20480
    v_mfma_f32_16x16x32_bf16 v[180:183], v[100:103], v[80:83], v[180:183]
    v_mfma_f32_16x16x32_bf16 v[200:203], v[100:103], v[84:87], v[200:203]
    buffer_load_dwordx4 v[68:71], v3, s[16:19], s32 offen sc1
    v_mfma_f32_16x16x32_bf16 v[220:223], v[100:103], v[88:91], v[220:223]
    v_mfma_f32_16x16x32_bf16 v[240:243], v[100:103], v[92:95], v[240:243]
    ds_read_b128 v[100:103], v13 offset:21504
    v_mfma_f32_16x16x32_bf16 v[184:187], v[104:107], v[80:83], v[184:187]
    v_mfma_f32_16x16x32_bf16 v[204:207], v[104:107], v[84:87], v[204:207]
    buffer_load_dwordx4 v[72:75], v4, s[16:19], s32 offen sc1
    v_mfma_f32_16x16x32_bf16 v[224:227], v[104:107], v[88:91], v[224:227]
    v_mfma_f32_16x16x32_bf16 v[244:247], v[104:107], v[92:95], v[244:247]
    ds_read_b128 v[104:107], v13 offset:22528
    v_mfma_f32_16x16x32_bf16 v[188:191], v[108:111], v[80:83], v[188:191]
    v_mfma_f32_16x16x32_bf16 v[208:211], v[108:111], v[84:87], v[208:211]
    buffer_load_dwordx4 v[76:79], v5, s[16:19], s32 offen sc1
    s_add_u32 s32, s32, 4096
    v_mfma_f32_16x16x32_bf16 v[228:231], v[108:111], v[88:91], v[228:231]
    v_mfma_f32_16x16x32_bf16 v[248:251], v[108:111], v[92:95], v[248:251]
    ds_read_b128 v[108:111], v13 offset:23552
    v_mfma_f32_16x16x32_bf16 v[192:195], v[112:115], v[80:83], v[192:195]
    v_mfma_f32_16x16x32_bf16 v[212:215], v[112:115], v[84:87], v[212:215]
    v_mfma_f32_16x16x32_bf16 v[232:235], v[112:115], v[88:91], v[232:235]
    v_mfma_f32_16x16x32_bf16 v[252:255], v[112:115], v[92:95], v[252:255]
    ds_read_b128 v[112:115], v13 offset:24576
    s_waitcnt vmcnt(13) lgkmcnt(15)
    v_mfma_f32_16x16x32_bf16 v[176:179], v[116:119], v[16:19], v[176:179]
    v_mfma_f32_16x16x32_bf16 v[196:199], v[116:119], v[20:23], v[196:199]
    buffer_load_dwordx4 v[80:83], v2, s[16:19], s32 offen sc1
    v_mfma_f32_16x16x32_bf16 v[216:219], v[116:119], v[24:27], v[216:219]
    v_mfma_f32_16x16x32_bf16 v[236:239], v[116:119], v[28:31], v[236:239]
    ds_read_b128 v[116:119], v13 offset:40960
    v_mfma_f32_16x16x32_bf16 v[180:183], v[120:123], v[16:19], v[180:183]
    v_mfma_f32_16x16x32_bf16 v[200:203], v[120:123], v[20:23], v[200:203]
    buffer_load_dwordx4 v[84:87], v3, s[16:19], s32 offen sc1
    v_mfma_f32_16x16x32_bf16 v[220:223], v[120:123], v[24:27], v[220:223]
    v_mfma_f32_16x16x32_bf16 v[240:243], v[120:123], v[28:31], v[240:243]
    ds_read_b128 v[120:123], v13 offset:41984
    v_mfma_f32_16x16x32_bf16 v[184:187], v[124:127], v[16:19], v[184:187]
    v_mfma_f32_16x16x32_bf16 v[204:207], v[124:127], v[20:23], v[204:207]
    buffer_load_dwordx4 v[88:91], v4, s[16:19], s32 offen sc1
    v_mfma_f32_16x16x32_bf16 v[224:227], v[124:127], v[24:27], v[224:227]
    v_mfma_f32_16x16x32_bf16 v[244:247], v[124:127], v[28:31], v[244:247]
    ds_read_b128 v[124:127], v13 offset:43008
    v_mfma_f32_16x16x32_bf16 v[188:191], v[128:131], v[16:19], v[188:191]
    v_mfma_f32_16x16x32_bf16 v[208:211], v[128:131], v[20:23], v[208:211]
    buffer_load_dwordx4 v[92:95], v5, s[16:19], s32 offen sc1
    s_add_u32 s32, s32, 4096
    v_mfma_f32_16x16x32_bf16 v[228:231], v[128:131], v[24:27], v[228:231]
    v_mfma_f32_16x16x32_bf16 v[248:251], v[128:131], v[28:31], v[248:251]
    ds_read_b128 v[128:131], v13 offset:44032
    v_mfma_f32_16x16x32_bf16 v[192:195], v[132:135], v[16:19], v[192:195]
    v_mfma_f32_16x16x32_bf16 v[212:215], v[132:135], v[20:23], v[212:215]
    v_mfma_f32_16x16x32_bf16 v[232:235], v[132:135], v[24:27], v[232:235]
    v_mfma_f32_16x16x32_bf16 v[252:255], v[132:135], v[28:31], v[252:255]
    ds_read_b128 v[132:135], v13 offset:45056
    s_waitcnt vmcnt(12) lgkmcnt(15)
    v_mfma_f32_16x16x32_bf16 v[176:179], v[136:139], v[32:35], v[176:179]
    v_mfma_f32_16x16x32_bf16 v[196:199], v[136:139], v[36:39], v[196:199]
    buffer_load_dwordx4 v[16:19], v2, s[16:19], s32 offen sc1
    v_mfma_f32_16x16x32_bf16 v[216:219], v[136:139], v[40:43], v[216:219]
    v_mfma_f32_16x16x32_bf16 v[236:239], v[136:139], v[44:47], v[236:239]
    ds_read_b128 v[136:139], v1 offset:10240
    v_mfma_f32_16x16x32_bf16 v[180:183], v[140:143], v[32:35], v[180:183]
    v_mfma_f32_16x16x32_bf16 v[200:203], v[140:143], v[36:39], v[200:203]
    buffer_load_dwordx4 v[20:23], v3, s[16:19], s32 offen sc1
    v_mfma_f32_16x16x32_bf16 v[220:223], v[140:143], v[40:43], v[220:223]
    v_mfma_f32_16x16x32_bf16 v[240:243], v[140:143], v[44:47], v[240:243]
    ds_read_b128 v[140:143], v1 offset:11264
    v_mfma_f32_16x16x32_bf16 v[184:187], v[144:147], v[32:35], v[184:187]
    v_mfma_f32_16x16x32_bf16 v[204:207], v[144:147], v[36:39], v[204:207]
    buffer_load_dwordx4 v[24:27], v4, s[16:19], s32 offen sc1
    v_mfma_f32_16x16x32_bf16 v[224:227], v[144:147], v[40:43], v[224:227]
    v_mfma_f32_16x16x32_bf16 v[244:247], v[144:147], v[44:47], v[244:247]
    ds_read_b128 v[144:147], v1 offset:12288
    v_mfma_f32_16x16x32_bf16 v[188:191], v[148:151], v[32:35], v[188:191]
    v_mfma_f32_16x16x32_bf16 v[208:211], v[148:151], v[36:39], v[208:211]
    buffer_load_dwordx4 v[28:31], v5, s[16:19], s32 offen sc1
    s_add_u32 s32, s32, 4096
    v_mfma_f32_16x16x32_bf16 v[228:231], v[148:151], v[40:43], v[228:231]
    v_mfma_f32_16x16x32_bf16 v[248:251], v[148:151], v[44:47], v[248:251]
    ds_read_b128 v[148:151], v1 offset:13312
    v_mfma_f32_16x16x32_bf16 v[192:195], v[152:155], v[32:35], v[192:195]
    v_mfma_f32_16x16x32_bf16 v[212:215], v[152:155], v[36:39], v[212:215]
    v_mfma_f32_16x16x32_bf16 v[232:235], v[152:155], v[40:43], v[232:235]
    v_mfma_f32_16x16x32_bf16 v[252:255], v[152:155], v[44:47], v[252:255]
    ds_read_b128 v[152:155], v1 offset:14336
    s_waitcnt vmcnt(12) lgkmcnt(15)
    v_mfma_f32_16x16x32_bf16 v[176:179], v[156:159], v[48:51], v[176:179]
    v_mfma_f32_16x16x32_bf16 v[196:199], v[156:159], v[52:55], v[196:199]
    buffer_load_dwordx4 v[32:35], v2, s[16:19], s32 offen sc1
    v_mfma_f32_16x16x32_bf16 v[216:219], v[156:159], v[56:59], v[216:219]
    v_mfma_f32_16x16x32_bf16 v[236:239], v[156:159], v[60:63], v[236:239]
    buffer_load_dwordx4 v[156:159], v6, s[16:19], s33 offen offset:0 sc1
    v_mfma_f32_16x16x32_bf16 v[180:183], v[160:163], v[48:51], v[180:183]
    v_mfma_f32_16x16x32_bf16 v[200:203], v[160:163], v[52:55], v[200:203]
    buffer_load_dwordx4 v[36:39], v3, s[16:19], s32 offen sc1
    v_mfma_f32_16x16x32_bf16 v[220:223], v[160:163], v[56:59], v[220:223]
    v_mfma_f32_16x16x32_bf16 v[240:243], v[160:163], v[60:63], v[240:243]
    buffer_load_dwordx4 v[160:163], v6, s[16:19], s33 offen offset:1024 sc1
    v_mfma_f32_16x16x32_bf16 v[184:187], v[164:167], v[48:51], v[184:187]
    v_mfma_f32_16x16x32_bf16 v[204:207], v[164:167], v[52:55], v[204:207]
    buffer_load_dwordx4 v[40:43], v4, s[16:19], s32 offen sc1
    v_mfma_f32_16x16x32_bf16 v[224:227], v[164:167], v[56:59], v[224:227]
    v_mfma_f32_16x16x32_bf16 v[244:247], v[164:167], v[60:63], v[244:247]
    buffer_load_dwordx4 v[164:167], v6, s[16:19], s33 offen offset:2048 sc1
    v_mfma_f32_16x16x32_bf16 v[188:191], v[168:171], v[48:51], v[188:191]
    v_mfma_f32_16x16x32_bf16 v[208:211], v[168:171], v[52:55], v[208:211]
    buffer_load_dwordx4 v[44:47], v5, s[16:19], s32 offen sc1
    s_add_u32 s32, s32, s57
    v_mfma_f32_16x16x32_bf16 v[228:231], v[168:171], v[56:59], v[228:231]
    v_mfma_f32_16x16x32_bf16 v[248:251], v[168:171], v[60:63], v[248:251]
    buffer_load_dwordx4 v[168:171], v6, s[16:19], s33 offen offset:3072 sc1
    v_mfma_f32_16x16x32_bf16 v[192:195], v[172:175], v[48:51], v[192:195]
    v_mfma_f32_16x16x32_bf16 v[212:215], v[172:175], v[52:55], v[212:215]
    v_mfma_f32_16x16x32_bf16 v[232:235], v[172:175], v[56:59], v[232:235]
    v_mfma_f32_16x16x32_bf16 v[252:255], v[172:175], v[60:63], v[252:255]
    buffer_load_dwordx4 v[172:175], v7, s[16:19], s33 offen offset:0 sc1
    s_add_u32 s33, s33, s58
    s_mov_b32 s52, s33
    s_add_u32 s33, s33, 20480
    s_add_u32 m0, s37, 61440
    s_nop 0
    buffer_load_dwordx4 v6, s[16:19], s33 offen offset:0 sc1 lds
    buffer_load_dwordx4 v6, s[16:19], s33 offen offset:1024 sc1 lds
    buffer_load_dwordx4 v6, s[16:19], s33 offen offset:2048 sc1 lds
    buffer_load_dwordx4 v6, s[16:19], s33 offen offset:3072 sc1 lds
    s_add_u32 m0, s37, 65536
    s_nop 0
    buffer_load_dwordx4 v7, s[16:19], s33 offen sc1 lds
    s_add_u32 s33, s33, 20480
    s_mov_b32 s33, s52
    s_waitcnt vmcnt(22) lgkmcnt(10)
    v_mfma_f32_16x16x32_bf16 v[176:179], v[96:99], v[64:67], v[176:179]
    v_mfma_f32_16x16x32_bf16 v[196:199], v[96:99], v[68:71], v[196:199]
    v_mfma_f32_16x16x32_bf16 v[216:219], v[96:99], v[72:75], v[216:219]
    v_mfma_f32_16x16x32_bf16 v[236:239], v[96:99], v[76:79], v[236:239]
    buffer_load_dwordx4 v[96:99], v6, s[16:19], s33 offen offset:0 sc1
    v_mfma_f32_16x16x32_bf16 v[180:183], v[100:103], v[64:67], v[180:183]
    v_mfma_f32_16x16x32_bf16 v[200:203], v[100:103], v[68:71], v[200:203]
    v_mfma_f32_16x16x32_bf16 v[220:223], v[100:103], v[72:75], v[220:223]
    v_mfma_f32_16x16x32_bf16 v[240:243], v[100:103], v[76:79], v[240:243]
    buffer_load_dwordx4 v[100:103], v6, s[16:19], s33 offen offset:1024 sc1
    v_mfma_f32_16x16x32_bf16 v[184:187], v[104:107], v[64:67], v[184:187]
    v_mfma_f32_16x16x32_bf16 v[204:207], v[104:107], v[68:71], v[204:207]
    v_mfma_f32_16x16x32_bf16 v[224:227], v[104:107], v[72:75], v[224:227]
    v_mfma_f32_16x16x32_bf16 v[244:247], v[104:107], v[76:79], v[244:247]
    buffer_load_dwordx4 v[104:107], v6, s[16:19], s33 offen offset:2048 sc1
    v_mfma_f32_16x16x32_bf16 v[188:191], v[108:111], v[64:67], v[188:191]
    v_mfma_f32_16x16x32_bf16 v[208:211], v[108:111], v[68:71], v[208:211]
    v_mfma_f32_16x16x32_bf16 v[228:231], v[108:111], v[72:75], v[228:231]
    v_mfma_f32_16x16x32_bf16 v[248:251], v[108:111], v[76:79], v[248:251]
    buffer_load_dwordx4 v[108:111], v6, s[16:19], s33 offen offset:3072 sc1
    v_mfma_f32_16x16x32_bf16 v[192:195], v[112:115], v[64:67], v[192:195]
    v_mfma_f32_16x16x32_bf16 v[212:215], v[112:115], v[68:71], v[212:215]
    v_mfma_f32_16x16x32_bf16 v[232:235], v[112:115], v[72:75], v[232:235]
    v_mfma_f32_16x16x32_bf16 v[252:255], v[112:115], v[76:79], v[252:255]
    buffer_load_dwordx4 v[112:115], v7, s[16:19], s33 offen offset:0 sc1
    s_add_u32 s33, s33, 5120
    buffer_load_dwordx4 v[48:51], v8, s[4:7], s34 offen offset:0
    buffer_load_dwordx4 v[52:55], v8, s[4:7], s34 offen offset:16
    buffer_load_dwordx2 v[56:57], v8, s[4:7], s34 offen offset:32
    buffer_load_dwordx4 v[58:61], v9, s[72:75], s35 offen offset:0
    buffer_load_dwordx4 v[62:65], v9, s[72:75], s35 offen offset:16
    buffer_load_dwordx2 v[66:67], v9, s[72:75], s35 offen offset:32
    s_waitcnt vmcnt(29) lgkmcnt(5)
    v_mfma_f32_16x16x32_bf16 v[176:179], v[116:119], v[80:83], v[176:179]
    v_mfma_f32_16x16x32_bf16 v[196:199], v[116:119], v[84:87], v[196:199]
    v_mfma_f32_16x16x32_bf16 v[216:219], v[116:119], v[88:91], v[216:219]
    v_mfma_f32_16x16x32_bf16 v[236:239], v[116:119], v[92:95], v[236:239]
    buffer_load_dwordx4 v[116:119], v6, s[16:19], s33 offen offset:0 sc1
    v_mfma_f32_16x16x32_bf16 v[180:183], v[120:123], v[80:83], v[180:183]
    v_mfma_f32_16x16x32_bf16 v[200:203], v[120:123], v[84:87], v[200:203]
    v_mfma_f32_16x16x32_bf16 v[220:223], v[120:123], v[88:91], v[220:223]
    v_mfma_f32_16x16x32_bf16 v[240:243], v[120:123], v[92:95], v[240:243]
    buffer_load_dwordx4 v[120:123], v6, s[16:19], s33 offen offset:1024 sc1
    v_mfma_f32_16x16x32_bf16 v[184:187], v[124:127], v[80:83], v[184:187]
    v_mfma_f32_16x16x32_bf16 v[204:207], v[124:127], v[84:87], v[204:207]
    v_mfma_f32_16x16x32_bf16 v[224:227], v[124:127], v[88:91], v[224:227]
    v_mfma_f32_16x16x32_bf16 v[244:247], v[124:127], v[92:95], v[244:247]
    buffer_load_dwordx4 v[124:127], v6, s[16:19], s33 offen offset:2048 sc1
    v_mfma_f32_16x16x32_bf16 v[188:191], v[128:131], v[80:83], v[188:191]
    v_mfma_f32_16x16x32_bf16 v[208:211], v[128:131], v[84:87], v[208:211]
    v_mfma_f32_16x16x32_bf16 v[228:231], v[128:131], v[88:91], v[228:231]
    v_mfma_f32_16x16x32_bf16 v[248:251], v[128:131], v[92:95], v[248:251]
    buffer_load_dwordx4 v[128:131], v6, s[16:19], s33 offen offset:3072 sc1
    v_mfma_f32_16x16x32_bf16 v[192:195], v[132:135], v[80:83], v[192:195]
    v_mfma_f32_16x16x32_bf16 v[212:215], v[132:135], v[84:87], v[212:215]
    v_mfma_f32_16x16x32_bf16 v[232:235], v[132:135], v[88:91], v[232:235]
    v_mfma_f32_16x16x32_bf16 v[252:255], v[132:135], v[92:95], v[252:255]
    buffer_load_dwordx4 v[132:135], v7, s[16:19], s33 offen offset:0 sc1
    s_add_u32 s33, s33, 5120
    s_waitcnt vmcnt(30) lgkmcnt(0)
    v_mfma_f32_16x16x32_bf16 v[176:179], v[136:139], v[16:19], v[176:179]
    v_mfma_f32_16x16x32_bf16 v[196:199], v[136:139], v[20:23], v[196:199]
    v_mfma_f32_16x16x32_bf16 v[216:219], v[136:139], v[24:27], v[216:219]
    v_mfma_f32_16x16x32_bf16 v[236:239], v[136:139], v[28:31], v[236:239]
    buffer_load_dwordx4 v[136:139], v6, s[16:19], s33 offen offset:0 sc1
    v_mfma_f32_16x16x32_bf16 v[180:183], v[140:143], v[16:19], v[180:183]
    v_mfma_f32_16x16x32_bf16 v[200:203], v[140:143], v[20:23], v[200:203]
    v_mfma_f32_16x16x32_bf16 v[220:223], v[140:143], v[24:27], v[220:223]
    v_mfma_f32_16x16x32_bf16 v[240:243], v[140:143], v[28:31], v[240:243]
    buffer_load_dwordx4 v[140:143], v6, s[16:19], s33 offen offset:1024 sc1
    v_mfma_f32_16x16x32_bf16 v[184:187], v[144:147], v[16:19], v[184:187]
    v_mfma_f32_16x16x32_bf16 v[204:207], v[144:147], v[20:23], v[204:207]
    v_mfma_f32_16x16x32_bf16 v[224:227], v[144:147], v[24:27], v[224:227]
    v_mfma_f32_16x16x32_bf16 v[244:247], v[144:147], v[28:31], v[244:247]
    buffer_load_dwordx4 v[144:147], v6, s[16:19], s33 offen offset:2048 sc1
    v_mfma_f32_16x16x32_bf16 v[188:191], v[148:151], v[16:19], v[188:191]
    v_mfma_f32_16x16x32_bf16 v[208:211], v[148:151], v[20:23], v[208:211]
    v_mfma_f32_16x16x32_bf16 v[228:231], v[148:151], v[24:27], v[228:231]
    v_mfma_f32_16x16x32_bf16 v[248:251], v[148:151], v[28:31], v[248:251]
    buffer_load_dwordx4 v[148:151], v6, s[16:19], s33 offen offset:3072 sc1
    v_mfma_f32_16x16x32_bf16 v[192:195], v[152:155], v[16:19], v[192:195]
    v_mfma_f32_16x16x32_bf16 v[212:215], v[152:155], v[20:23], v[212:215]
    v_mfma_f32_16x16x32_bf16 v[232:235], v[152:155], v[24:27], v[232:235]
    v_mfma_f32_16x16x32_bf16 v[252:255], v[152:155], v[28:31], v[252:255]
    buffer_load_dwordx4 v[152:155], v7, s[16:19], s33 offen offset:0 sc1
    s_add_u32 s33, s33, 5120
    s_waitcnt vmcnt(26)
    v_mfma_f32_16x16x32_bf16 v[176:179], v[156:159], v[32:35], v[176:179]
    v_mfma_f32_16x16x32_bf16 v[196:199], v[156:159], v[36:39], v[196:199]
    v_mfma_f32_16x16x32_bf16 v[216:219], v[156:159], v[40:43], v[216:219]
    v_mfma_f32_16x16x32_bf16 v[236:239], v[156:159], v[44:47], v[236:239]
    buffer_load_dwordx4 v[156:159], v6, s[16:19], s33 offen offset:0 sc1
    v_mfma_f32_16x16x32_bf16 v[180:183], v[160:163], v[32:35], v[180:183]
    v_mfma_f32_16x16x32_bf16 v[200:203], v[160:163], v[36:39], v[200:203]
    v_mfma_f32_16x16x32_bf16 v[220:223], v[160:163], v[40:43], v[220:223]
    v_mfma_f32_16x16x32_bf16 v[240:243], v[160:163], v[44:47], v[240:243]
    buffer_load_dwordx4 v[160:163], v6, s[16:19], s33 offen offset:1024 sc1
    v_mfma_f32_16x16x32_bf16 v[184:187], v[164:167], v[32:35], v[184:187]
    v_mfma_f32_16x16x32_bf16 v[204:207], v[164:167], v[36:39], v[204:207]
    v_mfma_f32_16x16x32_bf16 v[224:227], v[164:167], v[40:43], v[224:227]
    v_mfma_f32_16x16x32_bf16 v[244:247], v[164:167], v[44:47], v[244:247]
    buffer_load_dwordx4 v[164:167], v6, s[16:19], s33 offen offset:2048 sc1
    v_mfma_f32_16x16x32_bf16 v[188:191], v[168:171], v[32:35], v[188:191]
    v_mfma_f32_16x16x32_bf16 v[208:211], v[168:171], v[36:39], v[208:211]
    v_mfma_f32_16x16x32_bf16 v[228:231], v[168:171], v[40:43], v[228:231]
    v_mfma_f32_16x16x32_bf16 v[248:251], v[168:171], v[44:47], v[248:251]
    buffer_load_dwordx4 v[168:171], v6, s[16:19], s33 offen offset:3072 sc1
    v_mfma_f32_16x16x32_bf16 v[192:195], v[172:175], v[32:35], v[192:195]
    v_mfma_f32_16x16x32_bf16 v[212:215], v[172:175], v[36:39], v[212:215]
    v_mfma_f32_16x16x32_bf16 v[232:235], v[172:175], v[40:43], v[232:235]
    v_mfma_f32_16x16x32_bf16 v[252:255], v[172:175], v[44:47], v[252:255]
    buffer_load_dwordx4 v[172:175], v7, s[16:19], s33 offen offset:0 sc1
    s_add_u32 s33, s33, 5120
    v_and_b32 v0, 1, v14
    v_lshlrev_b32 v0, 7, v0
    buffer_load_dword v0, v0, s[16:19], s55 offen sc1
    s_waitcnt vmcnt(16)
    s_mov_b32 s39, 0xffff0000
    v_lshlrev_b32 v68, 16, v48
    v_and_b32 v69, s39, v48
    v_lshlrev_b32 v70, 16, v58
    v_and_b32 v71, s39, v58
    v_pk_add_f32 v[68:69], v[68:69], v[70:71]
    v_pk_add_f32 v[176:177], v[176:177], v[68:69]
    v_lshlrev_b32 v68, 16, v49
    v_and_b32 v69, s39, v49
    v_lshlrev_b32 v70, 16, v59
    v_and_b32 v71, s39, v59
    v_pk_add_f32 v[68:69], v[68:69], v[70:71]
    v_pk_add_f32 v[178:179], v[178:179], v[68:69]
    v_lshlrev_b32 v68, 16, v50
    v_and_b32 v69, s39, v50
    v_lshlrev_b32 v70, 16, v60
    v_and_b32 v71, s39, v60
    v_pk_add_f32 v[68:69], v[68:69], v[70:71]
    v_pk_add_f32 v[180:181], v[180:181], v[68:69]
    v_lshlrev_b32 v68, 16, v51
    v_and_b32 v69, s39, v51
    v_lshlrev_b32 v70, 16, v61
    v_and_b32 v71, s39, v61
    v_pk_add_f32 v[68:69], v[68:69], v[70:71]
    v_pk_add_f32 v[182:183], v[182:183], v[68:69]
    v_lshlrev_b32 v68, 16, v52
    v_and_b32 v69, s39, v52
    v_lshlrev_b32 v70, 16, v62
    v_and_b32 v71, s39, v62
    v_pk_add_f32 v[68:69], v[68:69], v[70:71]
    v_pk_add_f32 v[184:185], v[184:185], v[68:69]
    v_lshlrev_b32 v68, 16, v53
    v_and_b32 v69, s39, v53
    v_lshlrev_b32 v70, 16, v63
    v_and_b32 v71, s39, v63
    v_pk_add_f32 v[68:69], v[68:69], v[70:71]
    v_pk_add_f32 v[186:187], v[186:187], v[68:69]
    v_lshlrev_b32 v68, 16, v54
    v_and_b32 v69, s39, v54
    v_lshlrev_b32 v70, 16, v64
    v_and_b32 v71, s39, v64
    v_pk_add_f32 v[68:69], v[68:69], v[70:71]
    v_pk_add_f32 v[188:189], v[188:189], v[68:69]
    v_lshlrev_b32 v68, 16, v55
    v_and_b32 v69, s39, v55
    v_lshlrev_b32 v70, 16, v65
    v_and_b32 v71, s39, v65
    v_pk_add_f32 v[68:69], v[68:69], v[70:71]
    v_pk_add_f32 v[190:191], v[190:191], v[68:69]
    v_lshlrev_b32 v68, 16, v56
    v_and_b32 v69, s39, v56
    v_lshlrev_b32 v70, 16, v66
    v_and_b32 v71, s39, v66
    v_pk_add_f32 v[68:69], v[68:69], v[70:71]
    v_pk_add_f32 v[192:193], v[192:193], v[68:69]
    v_lshlrev_b32 v68, 16, v57
    v_and_b32 v69, s39, v57
    v_lshlrev_b32 v70, 16, v67
    v_and_b32 v71, s39, v67
    v_pk_add_f32 v[68:69], v[68:69], v[70:71]
    v_pk_add_f32 v[194:195], v[194:195], v[68:69]
    s_waitcnt vmcnt(0)
    v_cmp_eq_u32 vcc, s53, v0
    s_cmp_eq_u64 vcc, -1
    s_cbranch_scc1 F_fo1
    v_lshlrev_b32 v10, 7, v14
    s_mov_b32 s48, 0
    s_mov_b64 exec, 3
poll_11:
    buffer_load_dword v11, v10, s[16:19], s55 offen sc1
    s_add_u32 s48, s48, 1
    s_waitcnt vmcnt(0)
    v_cmp_eq_u32 vcc, s53, v11
    s_cmp_ge_u32 s48, 262144
    s_cbranch_scc1 poll_11_x
    s_cmp_eq_u64 vcc, 3
    s_cbranch_scc0 poll_11
poll_11_x:
    s_mov_b64 exec, -1
F_fo1:
    s_mov_b32 s56, s32
    buffer_load_dwordx4 v[48:51], v2, s[16:19], s32 offen sc1
    buffer_load_dwordx4 v[52:55], v3, s[16:19], s32 offen sc1
    buffer_load_dwordx4 v[56:59], v4, s[16:19], s32 offen sc1
    buffer_load_dwordx4 v[60:63], v5, s[16:19], s32 offen sc1
    s_add_u32 s32, s32, 1024
    buffer_load_dwordx4 v[64:67], v2, s[16:19], s32 offen sc1
    buffer_load_dwordx4 v[68:71], v3, s[16:19], s32 offen sc1
    buffer_load_dwordx4 v[72:75], v4, s[16:19], s32 offen sc1
    buffer_load_dwordx4 v[76:79], v5, s[16:19], s32 offen sc1
    s_add_u32 s32, s32, 1024
    buffer_load_dwordx4 v[80:83], v2, s[16:19], s32 offen sc1
    buffer_load_dwordx4 v[84:87], v3, s[16:19], s32 offen sc1
    buffer_load_dwordx4 v[88:91], v4, s[16:19], s32 offen sc1
    buffer_load_dwordx4 v[92:95], v5, s[16:19], s32 offen sc1
    s_add_u32 s32, s32, 1024
    buffer_load_dwordx4 v[16:19], v2, s[16:19], s32 offen sc1
    buffer_load_dwordx4 v[20:23], v3, s[16:19], s32 offen sc1
    buffer_load_dwordx4 v[24:27], v4, s[16:19], s32 offen sc1
    buffer_load_dwordx4 v[28:31], v5, s[16:19], s32 offen sc1
    s_add_u32 s32, s32, 1024
    buffer_load_dwordx4 v[32:35], v2, s[16:19], s32 offen sc1
    buffer_load_dwordx4 v[36:39], v3, s[16:19], s32 offen sc1
    buffer_load_dwordx4 v[40:43], v4, s[16:19], s32 offen sc1
    buffer_load_dwordx4 v[44:47], v5, s[16:19], s32 offen sc1
    s_add_u32 s32, s32, 1024
    s_mov_b32 s48, 0
    s_sub_u32 s36, s31, 1
    s_and_b32 s36, s36, 3
    s_mul_i32 s36, s36, 5120
    v_add_u32 v10, s36, v6
    s_sub_u32 s36, s31, 2
    s_and_b32 s36, s36, 3
    s_mul_i32 s36, s36, 5120
    v_add_u32 v11, s36, v6
    s_sub_u32 s36, s31, 3
    s_and_b32 s36, s36, 3
    s_mul_i32 s36, s36, 5120
    v_add_u32 v12, s36, v6
    s_waitcnt vmcnt(16)
    v_mfma_f32_16x16x32_bf16 v[176:179], v[96:99], v[48:51], v[176:179]
    v_mfma_f32_16x16x32_bf16 v[196:199], v[96:99], v[52:55], v[196:199]
    v_mfma_f32_16x16x32_bf16 v[216:219], v[96:99], v[56:59], v[216:219]
    v_mfma_f32_16x16x32_bf16 v[236:239], v[96:99], v[60:63], v[236:239]
    ds_read_b128 v[96:99], v13 offset:0
    v_mfma_f32_16x16x32_bf16 v[180:183], v[100:103], v[48:51], v[180:183]
    v_mfma_f32_16x16x32_bf16 v[200:203], v[100:103], v[52:55], v[200:203]
    v_mfma_f32_16x16x32_bf16 v[220:223], v[100:103], v[56:59], v[220:223]
    v_mfma_f32_16x16x32_bf16 v[240:243], v[100:103], v[60:63], v[240:243]
    ds_read_b128 v[100:103], v13 offset:1024
    v_mfma_f32_16x16x32_bf16 v[184:187], v[104:107], v[48:51], v[184:187]
    v_mfma_f32_16x16x32_bf16 v[204:207], v[104:107], v[52:55], v[204:207]
    v_mfma_f32_16x16x32_bf16 v[224:227], v[104:107], v[56:59], v[224:227]
    v_mfma_f32_16x16x32_bf16 v[244:247], v[104:107], v[60:63], v[244:247]
    ds_read_b128 v[104:107], v13 offset:2048
    v_mfma_f32_16x16x32_bf16 v[188:191], v[108:111], v[48:51], v[188:191]
    v_mfma_f32_16x16x32_bf16 v[208:211], v[108:111], v[52:55], v[208:211]
    v_mfma_f32_16x16x32_bf16 v[228:231], v[108:111], v[56:59], v[228:231]
    v_mfma_f32_16x16x32_bf16 v[248:251], v[108:111], v[60:63], v[248:251]
    ds_read_b128 v[108:111], v13 offset:3072
    v_mfma_f32_16x16x32_bf16 v[192:195], v[112:115], v[48:51], v[192:195]
    v_mfma_f32_16x16x32_bf16 v[212:215], v[112:115], v[52:55], v[212:215]
    v_mfma_f32_16x16x32_bf16 v[232:235], v[112:115], v[56:59], v[232:235]
    v_mfma_f32_16x16x32_bf16 v[252:255], v[112:115], v[60:63], v[252:255]
    ds_read_b128 v[112:115], v13 offset:4096
    s_waitcnt vmcnt(12)
    v_mfma_f32_16x16x32_bf16 v[176:179], v[116:119], v[64:67], v[176:179]
    v_mfma_f32_16x16x32_bf16 v[196:199], v[116:119], v[68:71], v[196:199]
    v_mfma_f32_16x16x32_bf16 v[216:219], v[116:119], v[72:75], v[216:219]
    v_mfma_f32_16x16x32_bf16 v[236:239], v[116:119], v[76:79], v[236:239]
    v_mfma_f32_16x16x32_bf16 v[180:183], v[120:123], v[64:67], v[180:183]
    v_mfma_f32_16x16x32_bf16 v[200:203], v[120:123], v[68:71], v[200:203]
    v_mfma_f32_16x16x32_bf16 v[220:223], v[120:123], v[72:75], v[220:223]
    v_mfma_f32_16x16x32_bf16 v[240:243], v[120:123], v[76:79], v[240:243]
    v_mfma_f32_16x16x32_bf16 v[184:187], v[124:127], v[64:67], v[184:187]
    v_mfma_f32_16x16x32_bf16 v[204:207], v[124:127], v[68:71], v[204:207]
    v_mfma_f32_16x16x32_bf16 v[224:227], v[124:127], v[72:75], v[224:227]
    v_mfma_f32_16x16x32_bf16 v[244:247], v[124:127], v[76:79], v[244:247]
    v_mfma_f32_16x16x32_bf16 v[188:191], v[128:131], v[64:67], v[188:191]
    v_mfma_f32_16x16x32_bf16 v[208:211], v[128:131], v[68:71], v[208:211]
    v_mfma_f32_16x16x32_bf16 v[228:231], v[128:131], v[72:75], v[228:231]
    v_mfma_f32_16x16x32_bf16 v[248:251], v[128:131], v[76:79], v[248:251]
    v_mfma_f32_16x16x32_bf16 v[192:195], v[132:135], v[64:67], v[192:195]
    v_mfma_f32_16x16x32_bf16 v[212:215], v[132:135], v[68:71], v[212:215]
    v_mfma_f32_16x16x32_bf16 v[232:235], v[132:135], v[72:75], v[232:235]
    v_mfma_f32_16x16x32_bf16 v[252:255], v[132:135], v[76:79], v[252:255]
    s_waitcnt vmcnt(8)
    v_mfma_f32_16x16x32_bf16 v[176:179], v[136:139], v[80:83], v[176:179]
    v_mfma_f32_16x16x32_bf16 v[196:199], v[136:139], v[84:87], v[196:199]
    v_mfma_f32_16x16x32_bf16 v[216:219], v[136:139], v[88:91], v[216:219]
    v_mfma_f32_16x16x32_bf16 v[236:239], v[136:139], v[92:95], v[236:239]
    v_mfma_f32_16x16x32_bf16 v[180:183], v[140:143], v[80:83], v[180:183]
    v_mfma_f32_16x16x32_bf16 v[200:203], v[140:143], v[84:87], v[200:203]
    v_mfma_f32_16x16x32_bf16 v[220:223], v[140:143], v[88:91], v[220:223]
    v_mfma_f32_16x16x32_bf16 v[240:243], v[140:143], v[92:95], v[240:243]
    v_mfma_f32_16x16x32_bf16 v[184:187], v[144:147], v[80:83], v[184:187]
    v_mfma_f32_16x16x32_bf16 v[204:207], v[144:147], v[84:87], v[204:207]
    v_mfma_f32_16x16x32_bf16 v[224:227], v[144:147], v[88:91], v[224:227]
    v_mfma_f32_16x16x32_bf16 v[244:247], v[144:147], v[92:95], v[244:247]
    v_mfma_f32_16x16x32_bf16 v[188:191], v[148:151], v[80:83], v[188:191]
    v_mfma_f32_16x16x32_bf16 v[208:211], v[148:151], v[84:87], v[208:211]
    v_mfma_f32_16x16x32_bf16 v[228:231], v[148:151], v[88:91], v[228:231]
    v_mfma_f32_16x16x32_bf16 v[248:251], v[148:151], v[92:95], v[248:251]
    v_mfma_f32_16x16x32_bf16 v[192:195], v[152:155], v[80:83], v[192:195]
    v_mfma_f32_16x16x32_bf16 v[212:215], v[152:155], v[84:87], v[212:215]
    v_mfma_f32_16x16x32_bf16 v[232:235], v[152:155], v[88:91], v[232:235]
    v_mfma_f32_16x16x32_bf16 v[252:255], v[152:155], v[92:95], v[252:255]
    s_waitcnt vmcnt(4)
    v_mfma_f32_16x16x32_bf16 v[176:179], v[156:159], v[16:19], v[176:179]
    v_mfma_f32_16x16x32_bf16 v[196:199], v[156:159], v[20:23], v[196:199]
    v_mfma_f32_16x16x32_bf16 v[216:219], v[156:159], v[24:27], v[216:219]
    v_mfma_f32_16x16x32_bf16 v[236:239], v[156:159], v[28:31], v[236:239]
    v_mfma_f32_16x16x32_bf16 v[180:183], v[160:163], v[16:19], v[180:183]
    v_mfma_f32_16x16x32_bf16 v[200:203], v[160:163], v[20:23], v[200:203]
    v_mfma_f32_16x16x32_bf16 v[220:223], v[160:163], v[24:27], v[220:223]
    v_mfma_f32_16x16x32_bf16 v[240:243], v[160:163], v[28:31], v[240:243]
    v_mfma_f32_16x16x32_bf16 v[184:187], v[164:167], v[16:19], v[184:187]
    v_mfma_f32_16x16x32_bf16 v[204:207], v[164:167], v[20:23], v[204:207]
    v_mfma_f32_16x16x32_bf16 v[224:227], v[164:167], v[24:27], v[224:227]
    v_mfma_f32_16x16x32_bf16 v[244:247], v[164:167], v[28:31], v[244:247]
    v_mfma_f32_16x16x32_bf16 v[188:191], v[168:171], v[16:19], v[188:191]
    v_mfma_f32_16x16x32_bf16 v[208:211], v[168:171], v[20:23], v[208:211]
    v_mfma_f32_16x16x32_bf16 v[228:231], v[168:171], v[24:27], v[228:231]
    v_mfma_f32_16x16x32_bf16 v[248:251], v[168:171], v[28:31], v[248:251]
    v_mfma_f32_16x16x32_bf16 v[192:195], v[172:175], v[16:19], v[192:195]
    v_mfma_f32_16x16x32_bf16 v[212:215], v[172:175], v[20:23], v[212:215]
    v_mfma_f32_16x16x32_bf16 v[232:235], v[172:175], v[24:27], v[232:235]
    v_mfma_f32_16x16x32_bf16 v[252:255], v[172:175], v[28:31], v[252:255]
    s_waitcnt vmcnt(0) lgkmcnt(0)
    v_mfma_f32_16x16x32_bf16 v[196:199], v[96:99], v[36:39], v[196:199]
    v_mfma_f32_16x16x32_bf16 v[200:203], v[100:103], v[36:39], v[200:203]
    v_mfma_f32_16x16x32_bf16 v[204:207], v[104:107], v[36:39], v[204:207]
    v_mfma_f32_16x16x32_bf16 v[208:211], v[108:111], v[36:39], v[208:211]
    v_mfma_f32_16x16x32_bf16 v[212:215], v[112:115], v[36:39], v[212:215]
    v_mfma_f32_16x16x32_bf16 v[216:219], v[96:99], v[40:43], v[216:219]
    s_nop 2
    ds_write_b128 v15, v[196:199] offset:0
    v_mfma_f32_16x16x32_bf16 v[220:223], v[100:103], v[40:43], v[220:223]
    ds_write_b128 v15, v[200:203] offset:1024
    v_mfma_f32_16x16x32_bf16 v[224:227], v[104:107], v[40:43], v[224:227]
    ds_write_b128 v15, v[204:207] offset:2048
    v_mfma_f32_16x16x32_bf16 v[228:231], v[108:111], v[40:43], v[228:231]
    ds_write_b128 v15, v[208:211] offset:3072
    v_mfma_f32_16x16x32_bf16 v[232:235], v[112:115], v[40:43], v[232:235]
    ds_write_b128 v15, v[212:215] offset:4096
    v_mfma_f32_16x16x32_bf16 v[236:239], v[96:99], v[44:47], v[236:239]
    ds_write_b128 v15, v[216:219] offset:20480
    v_mfma_f32_16x16x32_bf16 v[240:243], v[100:103], v[44:47], v[240:243]
    ds_write_b128 v15, v[220:223] offset:21504
    v_mfma_f32_16x16x32_bf16 v[244:247], v[104:107], v[44:47], v[244:247]
    ds_write_b128 v15, v[224:227] offset:22528
    v_mfma_f32_16x16x32_bf16 v[248:251], v[108:111], v[44:47], v[248:251]
    ds_write_b128 v15, v[228:231] offset:23552
    v_mfma_f32_16x16x32_bf16 v[252:255], v[112:115], v[44:47], v[252:255]
    ds_write_b128 v15, v[232:235] offset:24576
    v_mfma_f32_16x16x32_bf16 v[176:179], v[96:99], v[32:35], v[176:179]
    ds_write_b128 v15, v[236:239] offset:40960
    v_mfma_f32_16x16x32_bf16 v[180:183], v[100:103], v[32:35], v[180:183]
    ds_write_b128 v15, v[240:243] offset:41984
    v_mfma_f32_16x16x32_bf16 v[184:187], v[104:107], v[32:35], v[184:187]
    ds_write_b128 v15, v[244:247] offset:43008
    v_mfma_f32_16x16x32_bf16 v[188:191], v[108:111], v[32:35], v[188:191]
    ds_write_b128 v15, v[248:251] offset:44032
    v_mfma_f32_16x16x32_bf16 v[192:195], v[112:115], v[32:35], v[192:195]
    ds_write_b128 v15, v[252:255] offset:45056
F_p2_e:
    s_waitcnt lgkmcnt(0)
    s_barrier
    ds_read_b128 v[20:23], v10 offset:0
    ds_read_b128 v[24:27], v10 offset:1024
    ds_read_b128 v[28:31], v10 offset:2048
    ds_read_b128 v[32:35], v10 offset:3072
    ds_read_b128 v[36:39], v10 offset:4096
    ds_read_b128 v[40:43], v11 offset:20480
    ds_read_b128 v[44:47], v11 offset:21504
    ds_read_b128 v[48:51], v11 offset:22528
    ds_read_b128 v[52:55], v11 offset:23552
    ds_read_b128 v[56:59], v11 offset:24576
    ds_read_b128 v[60:63], v12 offset:40960
    ds_read_b128 v[64:67], v12 offset:41984
    ds_read_b128 v[68:71], v12 offset:43008
    ds_read_b128 v[72:75], v12 offset:44032
    ds_read_b128 v[76:79], v12 offset:45056
    s_waitcnt lgkmcnt(10)
    v_pk_add_f32 v[176:177], v[176:177], v[20:21]
    v_pk_add_f32 v[178:179], v[178:179], v[22:23]
    v_pk_add_f32 v[180:181], v[180:181], v[24:25]
    v_pk_add_f32 v[182:183], v[182:183], v[26:27]
    v_pk_add_f32 v[184:185], v[184:185], v[28:29]
    v_pk_add_f32 v[186:187], v[186:187], v[30:31]
    v_pk_add_f32 v[188:189], v[188:189], v[32:33]
    v_pk_add_f32 v[190:191], v[190:191], v[34:35]
    v_pk_add_f32 v[192:193], v[192:193], v[36:37]
    v_pk_add_f32 v[194:195], v[194:195], v[38:39]
    s_waitcnt lgkmcnt(5)
    v_pk_add_f32 v[176:177], v[176:177], v[40:41]
    v_pk_add_f32 v[178:179], v[178:179], v[42:43]
    v_pk_add_f32 v[180:181], v[180:181], v[44:45]
    v_pk_add_f32 v[182:183], v[182:183], v[46:47]
    v_pk_add_f32 v[184:185], v[184:185], v[48:49]
    v_pk_add_f32 v[186:187], v[186:187], v[50:51]
    v_pk_add_f32 v[188:189], v[188:189], v[52:53]
    v_pk_add_f32 v[190:191], v[190:191], v[54:55]
    v_pk_add_f32 v[192:193], v[192:193], v[56:57]
    v_pk_add_f32 v[194:195], v[194:195], v[58:59]
    s_waitcnt lgkmcnt(0)
    v_pk_add_f32 v[176:177], v[176:177], v[60:61]
    v_pk_add_f32 v[178:179], v[178:179], v[62:63]
    v_pk_add_f32 v[180:181], v[180:181], v[64:65]
    v_pk_add_f32 v[182:183], v[182:183], v[66:67]
    v_pk_add_f32 v[184:185], v[184:185], v[68:69]
    v_pk_add_f32 v[186:187], v[186:187], v[70:71]
    v_pk_add_f32 v[188:189], v[188:189], v[72:73]
    v_pk_add_f32 v[190:191], v[190:191], v[74:75]
    v_pk_add_f32 v[192:193], v[192:193], v[76:77]
    v_pk_add_f32 v[194:195], v[194:195], v[78:79]
    v_cvt_pk_bf16_f32 v176, v176, v177
    v_cvt_pk_bf16_f32 v177, v178, v179
    v_cvt_pk_bf16_f32 v178, v180, v181
    v_cvt_pk_bf16_f32 v179, v182, v183
    v_cvt_pk_bf16_f32 v180, v184, v185
    v_cvt_pk_bf16_f32 v181, v186, v187
    v_cvt_pk_bf16_f32 v182, v188, v189
    v_cvt_pk_bf16_f32 v183, v190, v191
    v_cvt_pk_bf16_f32 v184, v192, v193
    v_cvt_pk_bf16_f32 v185, v194, v195
    buffer_store_dwordx4 v[176:179], v8, s[68:71], s34 offen
    buffer_store_dwordx4 v[180:183], v8, s[68:71], s34 offen offset:16
    buffer_store_dwordx2 v[184:185], v8, s[68:71], s34 offen offset:32
    s_add_u32 s31, s31, 4
    s_endpgm
F_issue:
    s_lshl_b32 s34, s32, 7
    s_mul_i32 s35, s32, 245760
    s_mul_i32 s36, s32, 196608
    s_add_u32 s41, s33, s45
    s_add_u32 s42, s33, s46
    s_add_u32 s43, s33, s47
    s_add_u32 m0, s41, 0
    s_nop 0
    buffer_load_dwordx4 v10, s[4:7], s34 offen lds
    s_add_u32 m0, s41, 1024
    s_nop 0
    buffer_load_dwordx4 v11, s[4:7], s34 offen lds
    s_add_u32 m0, s41, 2048
    s_nop 0
    buffer_load_dwordx4 v12, s[4:7], s34 offen lds
    s_add_u32 m0, s41, 3072
    s_nop 0
    buffer_load_dwordx4 v13, s[4:7], s34 offen lds
    s_add_u32 m0, s42, 0
    s_nop 0
    buffer_load_dwordx4 v14, s[8:11], s35 offen lds
    s_add_u32 m0, s42, 1024
    s_nop 0
    buffer_load_dwordx4 v15, s[8:11], s35 offen lds
    s_add_u32 m0, s42, 2048
    s_nop 0
    buffer_load_dwordx4 v16, s[8:11], s35 offen lds
    s_add_u32 m0, s43, 0
    s_nop 0
    buffer_load_dwordx4 v19, s[12:15], s36 offen lds
    s_add_u32 m0, s43, 1024
    s_nop 0
    buffer_load_dwordx4 v20, s[12:15], s36 offen lds
    s_cmp_eq_u32 s30, 1
    s_cbranch_scc1 F_issue_b
    s_add_u32 m0, s42, 3072
    s_nop 0
    buffer_load_dwordx4 v17, s[8:11], s35 offen lds
    s_add_u32 m0, s42, 4096
    s_nop 0
    buffer_load_dwordx4 v18, s[8:11], s35 offen lds
    s_branch F_issue_e
F_issue_b:
    s_add_u32 m0, s43, 2048
    s_nop 0
    buffer_load_dwordx4 v21, s[12:15], s36 offen lds
    s_add_u32 m0, s43, 3072
    s_nop 0
    buffer_load_dwordx4 v22, s[12:15], s36 offen lds
F_issue_e:
    s_add_u32 s32, s32, 1
    s_cmp_eq_u32 s32, 10
    s_cselect_b32 s32, 0, s32
    s_add_u32 s33, s33, 45056
    s_cmp_eq_u32 s33, 135168
    s_cselect_b32 s33, 0, s33
    s_setpc_b64 s[56:57]
F_comp:
    s_lshl_b32 s33, s2, 2
    s_add_u32 s33, s33, s31
    s_cmp_eq_u32 s33, 3
    s_cbranch_scc0 F_nonce_x
    s_mov_b32 s34, 212992
    s_waitcnt lgkmcnt(0)
    s_buffer_load_dword s35, s[16:19], s34 glc
    v_mov_b32 v3, 0
    s_waitcnt lgkmcnt(0)
    s_add_u32 s35, s35, 1
    s_max_u32 s35, s35, 1
    v_mov_b32 v2, s35
    s_mov_b64 exec, 1
    buffer_store_dword v2, v3, s[76:79], 0 offen sc1
    buffer_store_dword v2, v3, s[16:19], s34 offen sc1
    s_mov_b64 exec, -1
F_nonce_x:
    s_cmp_ge_u32 s31, 2
    s_cbranch_scc1 P0_cols
    s_lshl_b32 s33, s2, 3
    s_lshl_b32 s34, s31, 2
    s_add_u32 s33, s33, s34
    v_lshrrev_b32 v65, 4, v60
    v_add_u32 v65, s33, v65
    v_and_b32 v66, 15, v60
    v_mul_u32_u24 v64, 1280, v65
    v_lshl_add_u32 v64, v66, 4, v64
    s_waitcnt lgkmcnt(0)
    buffer_load_dwordx4 v[20:23], v64, s[4:7], 0 offen offset:0
    buffer_load_dwordx4 v[24:27], v64, s[4:7], 0 offen offset:256
    buffer_load_dwordx4 v[28:31], v64, s[4:7], 0 offen offset:512
    buffer_load_dwordx4 v[32:35], v64, s[4:7], 0 offen offset:768
    buffer_load_dwordx4 v[36:39], v64, s[4:7], 0 offen offset:1024
    s_branch P0_issued
P0_cols:
    s_cmp_ge_u32 s2, 216
    s_cbranch_scc1 P0_issued
    s_lshr_b32 s33, s2, 2
    s_and_b32 s34, s2, 3
    s_lshl_b32 s34, s34, 1
    s_add_u32 s34, s34, s31
    s_sub_u32 s34, s34, 2
    s_mul_i32 s35, s34, 80
    v_lshrrev_b32 v76, 3, v60
    v_add_u32 v76, s35, v76
    v_and_b32 v77, 7, v60
    v_lshlrev_b32 v77, 4, v77
    s_cmp_ge_u32 s33, 30
    s_cbranch_scc1 P0_w1
    s_lshl_b32 s36, s33, 7
    v_mul_u32_u24 v76, 3840, v76
    v_add_u32 v76, v76, v77
    s_waitcnt lgkmcnt(0)
    buffer_load_dwordx4 v[20:23], v76, s[8:11], s36 offen
    s_add_u32 s36, s36, 30720
    buffer_load_dwordx4 v[24:27], v76, s[8:11], s36 offen
    s_add_u32 s36, s36, 30720
    buffer_load_dwordx4 v[28:31], v76, s[8:11], s36 offen
    s_add_u32 s36, s36, 30720
    buffer_load_dwordx4 v[32:35], v76, s[8:11], s36 offen
    s_add_u32 s36, s36, 30720
    buffer_load_dwordx4 v[36:39], v76, s[8:11], s36 offen
    s_add_u32 s36, s36, 30720
    buffer_load_dwordx4 v[40:43], v76, s[8:11], s36 offen
    s_add_u32 s36, s36, 30720
    buffer_load_dwordx4 v[44:47], v76, s[8:11], s36 offen
    s_add_u32 s36, s36, 30720
    buffer_load_dwordx4 v[48:51], v76, s[8:11], s36 offen
    s_add_u32 s36, s36, 30720
    buffer_load_dwordx4 v[52:55], v76, s[8:11], s36 offen
    s_add_u32 s36, s36, 30720
    buffer_load_dwordx4 v[56:59], v76, s[8:11], s36 offen
    s_add_u32 s36, s36, 30720
    s_branch P0_issued
P0_w1:
    s_sub_u32 s36, s33, 30
    s_lshl_b32 s36, s36, 7
    v_mul_u32_u24 v76, 3072, v76
    v_add_u32 v76, v76, v77
    s_waitcnt lgkmcnt(0)
    buffer_load_dwordx4 v[20:23], v76, s[12:15], s36 offen
    s_add_u32 s36, s36, 24576
    buffer_load_dwordx4 v[24:27], v76, s[12:15], s36 offen
    s_add_u32 s36, s36, 24576
    buffer_load_dwordx4 v[28:31], v76, s[12:15], s36 offen
    s_add_u32 s36, s36, 24576
    buffer_load_dwordx4 v[32:35], v76, s[12:15], s36 offen
    s_add_u32 s36, s36, 24576
    buffer_load_dwordx4 v[36:39], v76, s[12:15], s36 offen
    s_add_u32 s36, s36, 24576
    buffer_load_dwordx4 v[40:43], v76, s[12:15], s36 offen
    s_add_u32 s36, s36, 24576
    buffer_load_dwordx4 v[44:47], v76, s[12:15], s36 offen
    s_add_u32 s36, s36, 24576
    buffer_load_dwordx4 v[48:51], v76, s[12:15], s36 offen
    s_add_u32 s36, s36, 24576
    buffer_load_dwordx4 v[52:55], v76, s[12:15], s36 offen
    s_add_u32 s36, s36, 24576
    buffer_load_dwordx4 v[56:59], v76, s[12:15], s36 offen
    s_add_u32 s36, s36, 24576
P0_issued:
    v_lshrrev_b32 v61, 5, v60
    v_bfe_u32 v62, v60, 2, 2
    v_lshl_add_u32 v61, v61, 3, v62
    v_and_b32 v62, 1, v60
    v_bfe_u32 v63, v60, 4, 1
    v_bfe_u32 v2, v60, 1, 1
    v_lshl_add_u32 v63, v63, 1, v2
    v_and_b32 v2, 31, v60
    s_lshl_b32 s43, s31, 5
    v_add_u32 v2, s43, v2
    v_lshrrev_b32 v3, 5, v60
    v_bfe_u32 v4, v2, 1, 3
    v_xor_b32 v3, v3, v4
    v_lshlrev_b32 v3, 4, v3
    v_lshl_add_u32 v1, v2, 7, v3
    v_lshlrev_b32 v10, 2, v2
    v_add_u32 v10, 146688, v10
    v_add_u32 v1, 45056, v1
    v_xor_b32 v2, 32, v1
    v_xor_b32 v3, 64, v1
    v_xor_b32 v4, 96, v1
    v_lshrrev_b32 v12, 5, v60
    v_cmp_eq_u32 vcc, v12, v62
    v_bfe_u32 v13, v60, 2, 2
    v_mul_u32_u24 v13, 96, v13
    v_cndmask_b32 v12, 2, v12, vcc
    v_mul_u32_u24 v12, 3840, v12
    v_lshl_add_u32 v13, v63, 3, v13
    v_add_u32 v11, v12, v13
    v_add_u32 v11, 135168, v11
    s_cmp_eq_u32 s30, 1
    s_cbranch_scc1 F_as1
    v_mul_u32_u24 v5, 320, v61
    v_mul_u32_u24 v14, 160, v62
    v_lshlrev_b32 v15, 3, v63
    v_add3_u32 v5, v5, v14, v15
    v_add_u32 v5, 61440, v5
    v_lshlrev_b32 v6, 7, v61
    v_and_b32 v14, 16, v60
    v_lshlrev_b32 v14, 1, v14
    v_lshl_add_u32 v14, v62, 4, v14
    v_and_b32 v15, 2, v60
    v_lshl_add_u32 v14, v15, 2, v14
    v_add_u32 v6, v6, v14
    v_add_u32 v6, 81920, v6
    v_and_b32 v14, 8, v60
    v_lshl_add_u32 v6, v14, 3, v6
    v_xor_b32 v7, 64, v6
    s_lshl_b32 s43, s28, 3
    s_lshl_b32 s44, s31, 1
    s_add_u32 s43, s43, s44
    s_mul_i32 s43, s43, 69632
    s_mul_i32 s56, s29, 2560
    s_add_u32 s56, s56, s43
    s_add_u32 s56, s56, 8437760
    s_lshl_b32 s44, s29, 11
    s_add_u32 s43, s43, s44
    s_add_u32 s43, s43, 8421376
    v_and_b32 v15, 16, v60
    v_mul_u32_u24 v15, 4352, v15
    v_and_b32 v13, 15, v60
    v_lshl_add_u32 v15, v13, 4, v15
    v_and_b32 v13, 32, v60
    v_lshl_add_u32 v15, v13, 3, v15
    v_mov_b32 v16, -1
    v_mov_b32 v17, -1
    v_mov_b32 v18, -1
    v_mov_b32 v19, -1
    v_and_b32 v0, 31, v60
    s_lshl_b32 s44, s31, 5
    v_lshrrev_b32 v13, 5, v60
    v_mul_u32_u24 v63, 336, v13
    v_lshl_add_u32 v63, v0, 4, v63
    v_add_u32 v0, s44, v0
    v_mul_u32_u24 v0, 560, v0
    v_add_u32 v0, 40960, v0
    v_mul_u32_u24 v13, 80, v13
    v_add_u32 v8, v0, v13
    v_add_u32 v9, v8, v13
    v_mul_u32_u24 v72, 560, v61
    v_add_u32 v72, 40960, v72
    v_bfe_u32 v73, v60, 1, 1
    v_lshl_add_u32 v73, v62, 1, v73
    v_and_b32 v74, 16, v60
    v_cmp_eq_u32 vcc, 0, v74
    s_mul_i32 s44, s31, 80
    s_and_b32 s46, s31, 1
    v_cndmask_b32 v73, 4, v73, vcc
    v_lshl_add_u32 v61, v73, 3, v72
    v_add_u32 v61, s44, v61
    v_add_u32 v73, s46, v73
    v_cmp_eq_u32 vcc, 5, v73
    s_mul_i32 s44, s31, 40
    s_add_u32 s44, s44, 320
    v_cndmask_b32 v73, v73, 0, vcc
    v_lshl_add_u32 v73, v73, 3, s44
    v_and_b32 v74, 19, v60
    v_cmp_lt_u32 vcc, 16, v74
    v_mov_b32 v75, 480
    s_lshl_b32 s56, s29, 2
    s_add_u32 s56, s56, s31
    v_cndmask_b32 v73, v73, v75, vcc
    v_add_u32 v62, v73, v72
    s_lshl_b32 s56, s56, 4
    s_add_u32 s56, s56, s28
    s_mul_i32 s56, s56, 1792
    s_add_u32 s56, s56, 262144
    s_branch F_as2
F_as1:
    v_mul_u32_u24 v5, 192, v61
    v_mul_u32_u24 v14, 96, v62
    v_lshlrev_b32 v15, 3, v63
    v_add3_u32 v5, v5, v14, v15
    v_add_u32 v5, 61440, v5
    v_lshlrev_b32 v6, 8, v61
    v_and_b32 v14, 16, v60
    v_lshlrev_b32 v14, 1, v14
    v_lshl_add_u32 v14, v62, 4, v14
    v_and_b32 v15, 2, v60
    v_lshl_add_u32 v14, v15, 2, v14
    v_add_u32 v6, v6, v14
    v_add_u32 v6, 73728, v6
    v_and_b32 v14, 12, v60
    v_lshl_add_u32 v6, v14, 4, v6
    v_xor_b32 v7, 64, v6
    v_xor_b32 v8, 128, v6
    v_xor_b32 v9, 192, v6
    s_lshl_b32 s43, s28, 3
    s_lshl_b32 s44, s31, 1
    s_add_u32 s43, s43, s44
    s_mul_i32 s43, s43, 69632
    s_mul_i32 s56, s29, 2560
    s_add_u32 s56, s56, s43
    s_add_u32 s56, s56, 8437760
    s_lshl_b32 s44, s29, 12
    s_add_u32 s43, s43, s44
    s_add_u32 s43, s43, 8388608
    v_and_b32 v15, 16, v60
    v_mul_u32_u24 v15, 4352, v15
    v_and_b32 v13, 15, v60
    v_lshl_add_u32 v15, v13, 4, v15
    v_and_b32 v13, 32, v60
    v_lshl_add_u32 v15, v13, 3, v15
    v_mov_b32 v16, -1
    v_mov_b32 v17, -1
    v_mov_b32 v18, -1
    v_mov_b32 v19, -1
F_as2:
    v_mov_b32 v144, 0
    v_mov_b32 v145, 0
    v_mov_b32 v146, 0
    v_mov_b32 v147, 0
    v_mov_b32 v148, 0
    v_mov_b32 v149, 0
    v_mov_b32 v150, 0
    v_mov_b32 v151, 0
    v_mov_b32 v152, 0
    v_mov_b32 v153, 0
    v_mov_b32 v154, 0
    v_mov_b32 v155, 0
    v_mov_b32 v156, 0
    v_mov_b32 v157, 0
    v_mov_b32 v158, 0
    v_mov_b32 v159, 0
    v_mov_b32 v160, 0
    v_mov_b32 v161, 0
    v_mov_b32 v162, 0
    v_mov_b32 v163, 0
    v_mov_b32 v164, 0
    v_mov_b32 v165, 0
    v_mov_b32 v166, 0
    v_mov_b32 v167, 0
    v_mov_b32 v168, 0
    v_mov_b32 v169, 0
    v_mov_b32 v170, 0
    v_mov_b32 v171, 0
    v_mov_b32 v172, 0
    v_mov_b32 v173, 0
    v_mov_b32 v174, 0
    v_mov_b32 v175, 0
    v_mov_b32 v176, 0
    v_mov_b32 v177, 0
    v_mov_b32 v178, 0
    v_mov_b32 v179, 0
    v_mov_b32 v180, 0
    v_mov_b32 v181, 0
    v_mov_b32 v182, 0
    v_mov_b32 v183, 0
    v_mov_b32 v184, 0
    v_mov_b32 v185, 0
    v_mov_b32 v186, 0
    v_mov_b32 v187, 0
    v_mov_b32 v188, 0
    v_mov_b32 v189, 0
    v_mov_b32 v190, 0
    v_mov_b32 v191, 0
    v_mov_b32 v192, 0
    v_mov_b32 v193, 0
    v_mov_b32 v194, 0
    v_mov_b32 v195, 0
    v_mov_b32 v196, 0
    v_mov_b32 v197, 0
    v_mov_b32 v198, 0
    v_mov_b32 v199, 0
    v_mov_b32 v200, 0
    v_mov_b32 v201, 0
    v_mov_b32 v202, 0
    v_mov_b32 v203, 0
    v_mov_b32 v204, 0
    v_mov_b32 v205, 0
    v_mov_b32 v206, 0
    v_mov_b32 v207, 0
    v_mov_b32 v208, 0
    v_mov_b32 v209, 0
    v_mov_b32 v210, 0
    v_mov_b32 v211, 0
    v_mov_b32 v212, 0
    v_mov_b32 v213, 0
    v_mov_b32 v214, 0
    v_mov_b32 v215, 0
    v_mov_b32 v216, 0
    v_mov_b32 v217, 0
    v_mov_b32 v218, 0
    v_mov_b32 v219, 0
    v_mov_b32 v220, 0
    v_mov_b32 v221, 0
    v_mov_b32 v222, 0
    v_mov_b32 v223, 0
    v_mov_b32 v224, 0
    v_mov_b32 v225, 0
    v_mov_b32 v226, 0
    v_mov_b32 v227, 0
    v_mov_b32 v228, 0
    v_mov_b32 v229, 0
    v_mov_b32 v230, 0
    v_mov_b32 v231, 0
    v_mov_b32 v232, 0
    v_mov_b32 v233, 0
    v_mov_b32 v234, 0
    v_mov_b32 v235, 0
    v_mov_b32 v236, 0
    v_mov_b32 v237, 0
    v_mov_b32 v238, 0
    v_mov_b32 v239, 0
    v_mov_b32 v240, 0
    v_mov_b32 v241, 0
    v_mov_b32 v242, 0
    v_mov_b32 v243, 0
    v_mov_b32 v244, 0
    v_mov_b32 v245, 0
    v_mov_b32 v246, 0
    v_mov_b32 v247, 0
    v_mov_b32 v248, 0
    v_mov_b32 v249, 0
    v_mov_b32 v250, 0
    v_mov_b32 v251, 0
    v_mov_b32 v252, 0
    v_mov_b32 v253, 0
    v_mov_b32 v254, 0
    v_mov_b32 v255, 0
    s_waitcnt vmcnt(0)
    s_call_b64 s[58:59], P0_fin
    s_lshl_b32 s50, s28, 11
    s_lshl_b32 s55, s30, 3
    s_add_u32 s55, s55, s29
    s_lshl_b32 s55, s55, 7
    s_add_u32 s50, s50, s55
    s_add_u32 s50, s50, 2097152
    s_lshl_b32 s51, s29, 11
    s_lshl_b32 s55, s28, 7
    s_add_u32 s51, s51, s55
    s_add_u32 s51, s51, 2129920
    s_lshl_b32 s52, s28, 10
    s_lshl_b32 s55, s29, 7
    s_add_u32 s52, s52, s55
    s_add_u32 s52, s52, 2162688
    s_cmp_eq_u32 s30, 1
    s_cselect_b32 s51, s52, s51
    s_lshr_b32 s54, s2, 4
    s_lshl_b32 s54, s54, 7
    s_and_b32 s55, s2, 15
    s_lshl_b32 s55, s55, 2
    s_add_u32 s54, s54, s55
    s_add_u32 s54, s54, 204800
    s_waitcnt lgkmcnt(0)
    s_mov_b32 s40, 0
    s_mov_b32 s57, 276
    s_mov_b32 s42, 1
    s_mov_b32 s45, 45056
    s_cmp_eq_u32 s30, 1
    s_cbranch_scc1 F_c1
F_c0:
    s_barrier
    ds_read_b128 v[80:83], v1
    ds_read_b64_tr_b16 v[84:85], v5 offset:0
    ds_read_b64_tr_b16 v[86:87], v5 offset:1280
    ds_read_b64_tr_b16 v[88:89], v5 offset:32
    ds_read_b64_tr_b16 v[90:91], v5 offset:1312
    ds_read_b64_tr_b16 v[92:93], v5 offset:64
    ds_read_b64_tr_b16 v[94:95], v5 offset:1344
    ds_read_b64_tr_b16 v[96:97], v5 offset:96
    ds_read_b64_tr_b16 v[98:99], v5 offset:1376
    ds_read_b64_tr_b16 v[100:101], v5 offset:128
    ds_read_b64_tr_b16 v[102:103], v5 offset:1408
    ds_read_b64_tr_b16 v[104:105], v6 offset:0
    ds_read_b64_tr_b16 v[106:107], v6 offset:512
    ds_read_b64_tr_b16 v[108:109], v7 offset:0
    ds_read_b64_tr_b16 v[110:111], v7 offset:512
F_c0_loop:
    s_waitcnt lgkmcnt(0)
    v_mfma_f32_32x32x16_bf16 v[144:159], v[84:87], v[80:83], v[144:159]
    ds_read_b128 v[112:115], v2
    ds_read_b64_tr_b16 v[116:117], v5 offset:5120
    ds_read_b64_tr_b16 v[118:119], v5 offset:6400
    v_mfma_f32_32x32x16_bf16 v[160:175], v[88:91], v[80:83], v[160:175]
    ds_read_b64_tr_b16 v[120:121], v5 offset:5152
    ds_read_b64_tr_b16 v[122:123], v5 offset:6432
    ds_read_b64_tr_b16 v[124:125], v5 offset:5184
    v_mfma_f32_32x32x16_bf16 v[176:191], v[92:95], v[80:83], v[176:191]
    ds_read_b64_tr_b16 v[126:127], v5 offset:6464
    ds_read_b64_tr_b16 v[128:129], v5 offset:5216
    ds_read_b64_tr_b16 v[130:131], v5 offset:6496
    v_mfma_f32_32x32x16_bf16 v[192:207], v[96:99], v[80:83], v[192:207]
    ds_read_b64_tr_b16 v[132:133], v5 offset:5248
    ds_read_b64_tr_b16 v[134:135], v5 offset:6528
    ds_read_b64_tr_b16 v[136:137], v6 offset:2048
    v_mfma_f32_32x32x16_bf16 v[208:223], v[100:103], v[80:83], v[208:223]
    ds_read_b64_tr_b16 v[138:139], v6 offset:2560
    ds_read_b64_tr_b16 v[140:141], v7 offset:2048
    ds_read_b64_tr_b16 v[142:143], v7 offset:2560
    v_mfma_f32_32x32x16_bf16 v[224:239], v[104:107], v[80:83], v[224:239]
    v_mfma_f32_32x32x16_bf16 v[240:255], v[108:111], v[80:83], v[240:255]
    s_waitcnt lgkmcnt(0)
    v_mfma_f32_32x32x16_bf16 v[144:159], v[116:119], v[112:115], v[144:159]
    ds_read_b128 v[80:83], v3
    ds_read_b64_tr_b16 v[84:85], v5 offset:10240
    ds_read_b64_tr_b16 v[86:87], v5 offset:11520
    v_mfma_f32_32x32x16_bf16 v[160:175], v[120:123], v[112:115], v[160:175]
    ds_read_b64_tr_b16 v[88:89], v5 offset:10272
    ds_read_b64_tr_b16 v[90:91], v5 offset:11552
    ds_read_b64_tr_b16 v[92:93], v5 offset:10304
    v_mfma_f32_32x32x16_bf16 v[176:191], v[124:127], v[112:115], v[176:191]
    ds_read_b64_tr_b16 v[94:95], v5 offset:11584
    ds_read_b64_tr_b16 v[96:97], v5 offset:10336
    ds_read_b64_tr_b16 v[98:99], v5 offset:11616
    v_mfma_f32_32x32x16_bf16 v[192:207], v[128:131], v[112:115], v[192:207]
    ds_read_b64_tr_b16 v[100:101], v5 offset:10368
    ds_read_b64_tr_b16 v[102:103], v5 offset:11648
    ds_read_b64_tr_b16 v[104:105], v6 offset:4096
    v_mfma_f32_32x32x16_bf16 v[208:223], v[132:135], v[112:115], v[208:223]
    ds_read_b64_tr_b16 v[106:107], v6 offset:4608
    ds_read_b64_tr_b16 v[108:109], v7 offset:4096
    ds_read_b64_tr_b16 v[110:111], v7 offset:4608
    v_mfma_f32_32x32x16_bf16 v[224:239], v[136:139], v[112:115], v[224:239]
    v_mfma_f32_32x32x16_bf16 v[240:255], v[140:143], v[112:115], v[240:255]
    s_waitcnt lgkmcnt(0)
    v_mfma_f32_32x32x16_bf16 v[144:159], v[84:87], v[80:83], v[144:159]
    ds_read_b128 v[112:115], v4
    ds_read_b64_tr_b16 v[116:117], v5 offset:15360
    ds_read_b64_tr_b16 v[118:119], v5 offset:16640
    v_mfma_f32_32x32x16_bf16 v[160:175], v[88:91], v[80:83], v[160:175]
    ds_read_b64_tr_b16 v[120:121], v5 offset:15392
    ds_read_b64_tr_b16 v[122:123], v5 offset:16672
    ds_read_b64_tr_b16 v[124:125], v5 offset:15424
    v_mfma_f32_32x32x16_bf16 v[176:191], v[92:95], v[80:83], v[176:191]
    ds_read_b64_tr_b16 v[126:127], v5 offset:16704
    ds_read_b64_tr_b16 v[128:129], v5 offset:15456
    ds_read_b64_tr_b16 v[130:131], v5 offset:16736
    v_mfma_f32_32x32x16_bf16 v[192:207], v[96:99], v[80:83], v[192:207]
    ds_read_b64_tr_b16 v[132:133], v5 offset:15488
    ds_read_b64_tr_b16 v[134:135], v5 offset:16768
    ds_read_b64_tr_b16 v[136:137], v6 offset:6144
    v_mfma_f32_32x32x16_bf16 v[208:223], v[100:103], v[80:83], v[208:223]
    ds_read_b64_tr_b16 v[138:139], v6 offset:6656
    ds_read_b64_tr_b16 v[140:141], v7 offset:6144
    ds_read_b64_tr_b16 v[142:143], v7 offset:6656
    v_mfma_f32_32x32x16_bf16 v[224:239], v[104:107], v[80:83], v[224:239]
    s_cmp_eq_u32 s42, 2
    s_cselect_b32 s41, -90112, s45
    s_add_u32 s42, s42, 1
    s_cmp_eq_u32 s42, 3
    s_cselect_b32 s42, 0, s42
    s_bitcmp1_b32 s57, s40
    v_mfma_f32_32x32x16_bf16 v[240:255], v[108:111], v[80:83], v[240:255]
    s_cbranch_scc1 F_c0_it2
    s_waitcnt lgkmcnt(0)
    s_barrier
F_c0_it2r:
    v_mfma_f32_32x32x16_bf16 v[144:159], v[116:119], v[112:115], v[144:159]
    v_add_u32 v1, s41, v1
    v_add_u32 v5, s41, v5
    ds_read_b128 v[80:83], v1
    ds_read_b64_tr_b16 v[84:85], v5 offset:0
    ds_read_b64_tr_b16 v[86:87], v5 offset:1280
    v_mfma_f32_32x32x16_bf16 v[160:175], v[120:123], v[112:115], v[160:175]
    v_add_u32 v6, s41, v6
    v_add_u32 v7, s41, v7
    ds_read_b64_tr_b16 v[88:89], v5 offset:32
    ds_read_b64_tr_b16 v[90:91], v5 offset:1312
    ds_read_b64_tr_b16 v[92:93], v5 offset:64
    v_mfma_f32_32x32x16_bf16 v[176:191], v[124:127], v[112:115], v[176:191]
    v_add_u32 v2, s41, v2
    v_add_u32 v3, s41, v3
    v_add_u32 v4, s41, v4
    ds_read_b64_tr_b16 v[94:95], v5 offset:1344
    ds_read_b64_tr_b16 v[96:97], v5 offset:96
    ds_read_b64_tr_b16 v[98:99], v5 offset:1376
    v_mfma_f32_32x32x16_bf16 v[192:207], v[128:131], v[112:115], v[192:207]
    ds_read_b64_tr_b16 v[100:101], v5 offset:128
    ds_read_b64_tr_b16 v[102:103], v5 offset:1408
    ds_read_b64_tr_b16 v[104:105], v6 offset:0
    v_mfma_f32_32x32x16_bf16 v[208:223], v[132:135], v[112:115], v[208:223]
    ds_read_b64_tr_b16 v[106:107], v6 offset:512
    ds_read_b64_tr_b16 v[108:109], v7 offset:0
    ds_read_b64_tr_b16 v[110:111], v7 offset:512
    v_mfma_f32_32x32x16_bf16 v[224:239], v[136:139], v[112:115], v[224:239]
    s_add_u32 s40, s40, 1
    s_cmp_lt_u32 s40, 10
    v_mfma_f32_32x32x16_bf16 v[240:255], v[140:143], v[112:115], v[240:255]
    s_cbranch_scc1 F_c0_loop
    s_setprio 3
    s_waitcnt lgkmcnt(0)
    v_mfma_f32_32x32x16_bf16 v[144:159], v[84:87], v[80:83], v[144:159]
    ds_read_b32 v10, v10
    ds_read_b64_tr_b16 v[16:17], v11 offset:0
    ds_read_b64_tr_b16 v[18:19], v11 offset:384
    ds_read_b64_tr_b16 v[20:21], v11 offset:32
    v_mfma_f32_32x32x16_bf16 v[160:175], v[88:91], v[80:83], v[160:175]
    ds_read_b64_tr_b16 v[22:23], v11 offset:416
    ds_read_b64_tr_b16 v[24:25], v11 offset:768
    ds_read_b64_tr_b16 v[26:27], v11 offset:1152
    ds_read_b64_tr_b16 v[28:29], v11 offset:800
    v_mfma_f32_32x32x16_bf16 v[176:191], v[92:95], v[80:83], v[176:191]
    ds_read_b64_tr_b16 v[30:31], v11 offset:1184
    ds_read_b64_tr_b16 v[32:33], v11 offset:1600
    ds_read_b64_tr_b16 v[34:35], v11 offset:1984
    ds_read_b64_tr_b16 v[36:37], v11 offset:1536
    v_mfma_f32_32x32x16_bf16 v[192:207], v[96:99], v[80:83], v[192:207]
    ds_read_b64_tr_b16 v[38:39], v11 offset:1920
    ds_read_b64_tr_b16 v[40:41], v11 offset:1568
    ds_read_b64_tr_b16 v[42:43], v11 offset:1952
    ds_read_b64_tr_b16 v[44:45], v11 offset:2368
    v_mfma_f32_32x32x16_bf16 v[208:223], v[100:103], v[80:83], v[208:223]
    ds_read_b64_tr_b16 v[46:47], v11 offset:2752
    ds_read_b64_tr_b16 v[48:49], v11 offset:2336
    ds_read_b64_tr_b16 v[50:51], v11 offset:2720
    ds_read_b64_tr_b16 v[52:53], v11 offset:3136
    v_mfma_f32_32x32x16_bf16 v[224:239], v[104:107], v[80:83], v[224:239]
    ds_read_b64_tr_b16 v[54:55], v11 offset:3520
    ds_read_b64_tr_b16 v[56:57], v11 offset:3104
    ds_read_b64_tr_b16 v[58:59], v11 offset:3488
    v_mfma_f32_32x32x16_bf16 v[240:255], v[108:111], v[80:83], v[240:255]
    v_cvt_pk_bf16_f32 v112, v144, v145
    v_cvt_pk_bf16_f32 v113, v146, v147
    v_cvt_pk_bf16_f32 v114, v148, v149
    v_cvt_pk_bf16_f32 v115, v150, v151
    v_cvt_pk_bf16_f32 v116, v152, v153
    v_cvt_pk_bf16_f32 v117, v154, v155
    v_cvt_pk_bf16_f32 v118, v156, v157
    v_cvt_pk_bf16_f32 v119, v158, v159
    v_cvt_pk_bf16_f32 v120, v160, v161
    v_cvt_pk_bf16_f32 v121, v162, v163
    v_cvt_pk_bf16_f32 v122, v164, v165
    v_cvt_pk_bf16_f32 v123, v166, v167
    v_cvt_pk_bf16_f32 v124, v168, v169
    v_cvt_pk_bf16_f32 v125, v170, v171
    v_cvt_pk_bf16_f32 v126, v172, v173
    v_cvt_pk_bf16_f32 v127, v174, v175
    v_cvt_pk_bf16_f32 v128, v176, v177
    v_cvt_pk_bf16_f32 v129, v178, v179
    v_cvt_pk_bf16_f32 v130, v180, v181
    v_cvt_pk_bf16_f32 v131, v182, v183
    s_waitcnt lgkmcnt(0)
    s_barrier
    v_mfma_f32_32x32x16_bf16 v[64:79], v[16:19], v[112:115], 0
    v_mfma_f32_32x32x16_bf16 v[80:95], v[20:23], v[112:115], 0
    v_mfma_f32_32x32x16_bf16 v[64:79], v[24:27], v[116:119], v[64:79]
    v_mul_f32 v12, 0x3fb8aa3b, v10
    v_mul_f32 v14, v10, v10
    v_max_f32 v224, 0, v224
    v_max_f32 v225, 0, v225
    v_max_f32 v226, 0, v226
    v_max_f32 v227, 0, v227
    v_mfma_f32_32x32x16_bf16 v[80:95], v[28:31], v[116:119], v[80:95]
    v_max_f32 v228, 0, v228
    v_max_f32 v229, 0, v229
    v_max_f32 v230, 0, v230
    v_max_f32 v231, 0, v231
    v_pk_mul_f32 v[136:137], v[224:225], v[14:15] op_sel_hi:[1,0]
    v_pk_mul_f32 v[138:139], v[226:227], v[14:15] op_sel_hi:[1,0]
    v_mfma_f32_32x32x16_bf16 v[96:111], v[32:35], v[120:123], 0
    v_pk_mul_f32 v[140:141], v[228:229], v[14:15] op_sel_hi:[1,0]
    v_pk_mul_f32 v[142:143], v[230:231], v[14:15] op_sel_hi:[1,0]
    v_pk_mul_f32 v[224:225], v[136:137], v[224:225]
    v_pk_mul_f32 v[226:227], v[138:139], v[226:227]
    v_pk_mul_f32 v[228:229], v[140:141], v[228:229]
    v_pk_mul_f32 v[230:231], v[142:143], v[230:231]
    v_mfma_f32_32x32x16_bf16 v[64:79], v[36:39], v[120:123], v[64:79]
    v_cvt_pk_bf16_f32 v224, v224, v225
    v_cvt_pk_bf16_f32 v225, v226, v227
    v_cvt_pk_bf16_f32 v226, v228, v229
    v_cvt_pk_bf16_f32 v227, v230, v231
    buffer_store_dwordx4 v[224:227], v15, s[16:19], s43 offen offset:0 sc1
    v_max_f32 v232, 0, v232
    v_mfma_f32_32x32x16_bf16 v[80:95], v[40:43], v[120:123], v[80:95]
    v_max_f32 v233, 0, v233
    v_max_f32 v234, 0, v234
    v_max_f32 v235, 0, v235
    v_max_f32 v236, 0, v236
    v_max_f32 v237, 0, v237
    v_max_f32 v238, 0, v238
    v_mfma_f32_32x32x16_bf16 v[96:111], v[44:47], v[124:127], v[96:111]
    v_max_f32 v239, 0, v239
    v_pk_mul_f32 v[136:137], v[232:233], v[14:15] op_sel_hi:[1,0]
    v_pk_mul_f32 v[138:139], v[234:235], v[14:15] op_sel_hi:[1,0]
    v_pk_mul_f32 v[140:141], v[236:237], v[14:15] op_sel_hi:[1,0]
    v_pk_mul_f32 v[142:143], v[238:239], v[14:15] op_sel_hi:[1,0]
    v_pk_mul_f32 v[232:233], v[136:137], v[232:233]
    v_mfma_f32_32x32x16_bf16 v[80:95], v[48:51], v[124:127], v[80:95]
    v_pk_mul_f32 v[234:235], v[138:139], v[234:235]
    v_pk_mul_f32 v[236:237], v[140:141], v[236:237]
    v_pk_mul_f32 v[238:239], v[142:143], v[238:239]
    v_cvt_pk_bf16_f32 v232, v232, v233
    v_cvt_pk_bf16_f32 v233, v234, v235
    v_cvt_pk_bf16_f32 v234, v236, v237
    v_mfma_f32_32x32x16_bf16 v[96:111], v[52:55], v[128:131], v[96:111]
    v_cvt_pk_bf16_f32 v235, v238, v239
    buffer_store_dwordx4 v[232:235], v15, s[16:19], s43 offen offset:512 sc1
    v_max_f32 v240, 0, v240
    v_max_f32 v241, 0, v241
    v_max_f32 v242, 0, v242
    v_max_f32 v243, 0, v243
    v_mfma_f32_32x32x16_bf16 v[80:95], v[56:59], v[128:131], v[80:95]
    v_max_f32 v244, 0, v244
    v_max_f32 v245, 0, v245
    v_max_f32 v246, 0, v246
    v_max_f32 v247, 0, v247
    v_pk_mul_f32 v[136:137], v[240:241], v[14:15] op_sel_hi:[1,0]
    v_pk_mul_f32 v[138:139], v[242:243], v[14:15] op_sel_hi:[1,0]
    v_pk_mul_f32 v[140:141], v[244:245], v[14:15] op_sel_hi:[1,0]
    v_pk_mul_f32 v[142:143], v[246:247], v[14:15] op_sel_hi:[1,0]
    v_pk_mul_f32 v[240:241], v[136:137], v[240:241]
    v_pk_mul_f32 v[242:243], v[138:139], v[242:243]
    v_pk_mul_f32 v[244:245], v[140:141], v[244:245]
    v_pk_mul_f32 v[246:247], v[142:143], v[246:247]
    v_cvt_pk_bf16_f32 v240, v240, v241
    v_cvt_pk_bf16_f32 v241, v242, v243
    v_cvt_pk_bf16_f32 v242, v244, v245
    v_cvt_pk_bf16_f32 v243, v246, v247
    buffer_store_dwordx4 v[240:243], v15, s[16:19], s43 offen offset:1024 sc1
    v_max_f32 v248, 0, v248
    v_max_f32 v249, 0, v249
    v_max_f32 v250, 0, v250
    v_max_f32 v251, 0, v251
    v_max_f32 v252, 0, v252
    v_max_f32 v253, 0, v253
    v_max_f32 v254, 0, v254
    v_max_f32 v255, 0, v255
    v_pk_mul_f32 v[136:137], v[248:249], v[14:15] op_sel_hi:[1,0]
    v_pk_mul_f32 v[138:139], v[250:251], v[14:15] op_sel_hi:[1,0]
    v_pk_mul_f32 v[140:141], v[252:253], v[14:15] op_sel_hi:[1,0]
    v_pk_mul_f32 v[142:143], v[254:255], v[14:15] op_sel_hi:[1,0]
    v_pk_mul_f32 v[248:249], v[136:137], v[248:249]
    v_pk_mul_f32 v[250:251], v[138:139], v[250:251]
    v_pk_mul_f32 v[252:253], v[140:141], v[252:253]
    v_pk_mul_f32 v[254:255], v[142:143], v[254:255]
    v_cvt_pk_bf16_f32 v248, v248, v249
    v_cvt_pk_bf16_f32 v249, v250, v251
    v_cvt_pk_bf16_f32 v250, v252, v253
    v_cvt_pk_bf16_f32 v251, v254, v255
    buffer_store_dwordx4 v[248:251], v15, s[16:19], s43 offen offset:1536 sc1
    v_pk_mul_f32 v[184:185], v[184:185], v[10:11] op_sel_hi:[1,0]
    v_cvt_pk_bf16_f32 v184, v184, v185
    v_pk_mul_f32 v[186:187], v[186:187], v[10:11] op_sel_hi:[1,0]
    v_cvt_pk_bf16_f32 v185, v186, v187
    v_pk_mul_f32 v[188:189], v[188:189], v[10:11] op_sel_hi:[1,0]
    v_cvt_pk_bf16_f32 v186, v188, v189
    v_pk_mul_f32 v[190:191], v[190:191], v[10:11] op_sel_hi:[1,0]
    v_cvt_pk_bf16_f32 v187, v190, v191
    v_pk_mul_f32 v[192:193], v[192:193], v[10:11] op_sel_hi:[1,0]
    v_cvt_pk_bf16_f32 v188, v192, v193
    v_pk_mul_f32 v[194:195], v[194:195], v[10:11] op_sel_hi:[1,0]
    v_cvt_pk_bf16_f32 v189, v194, v195
    v_pk_mul_f32 v[196:197], v[196:197], v[10:11] op_sel_hi:[1,0]
    v_cvt_pk_bf16_f32 v190, v196, v197
    v_pk_mul_f32 v[198:199], v[198:199], v[10:11] op_sel_hi:[1,0]
    v_cvt_pk_bf16_f32 v191, v198, v199
    v_pk_mul_f32 v[200:201], v[200:201], v[10:11] op_sel_hi:[1,0]
    v_cvt_pk_bf16_f32 v192, v200, v201
    v_pk_mul_f32 v[202:203], v[202:203], v[10:11] op_sel_hi:[1,0]
    v_cvt_pk_bf16_f32 v193, v202, v203
    v_pk_mul_f32 v[204:205], v[204:205], v[10:11] op_sel_hi:[1,0]
    v_cvt_pk_bf16_f32 v194, v204, v205
    v_pk_mul_f32 v[206:207], v[206:207], v[10:11] op_sel_hi:[1,0]
    v_cvt_pk_bf16_f32 v195, v206, v207
    v_pk_mul_f32 v[208:209], v[208:209], v[10:11] op_sel_hi:[1,0]
    v_cvt_pk_bf16_f32 v196, v208, v209
    v_pk_mul_f32 v[210:211], v[210:211], v[10:11] op_sel_hi:[1,0]
    v_cvt_pk_bf16_f32 v197, v210, v211
    v_pk_mul_f32 v[212:213], v[212:213], v[10:11] op_sel_hi:[1,0]
    v_cvt_pk_bf16_f32 v198, v212, v213
    v_pk_mul_f32 v[214:215], v[214:215], v[10:11] op_sel_hi:[1,0]
    v_cvt_pk_bf16_f32 v199, v214, v215
    v_pk_mul_f32 v[216:217], v[216:217], v[10:11] op_sel_hi:[1,0]
    v_cvt_pk_bf16_f32 v200, v216, v217
    v_pk_mul_f32 v[218:219], v[218:219], v[10:11] op_sel_hi:[1,0]
    v_cvt_pk_bf16_f32 v201, v218, v219
    v_pk_mul_f32 v[220:221], v[220:221], v[10:11] op_sel_hi:[1,0]
    v_cvt_pk_bf16_f32 v202, v220, v221
    v_pk_mul_f32 v[222:223], v[222:223], v[10:11] op_sel_hi:[1,0]
    v_cvt_pk_bf16_f32 v203, v222, v223
    ds_write_b128 v8, v[184:187] offset:320
    ds_write_b128 v8, v[188:191] offset:336
    ds_write_b128 v8, v[192:195] offset:352
    ds_write_b128 v8, v[196:199] offset:368
    ds_write_b128 v8, v[200:203] offset:384
    v_mov_b32 v2, 0x3f80
    v_mov_b32 v3, 0
    ds_write_b64 v0, v[2:3] offset:480
    v_max3_f32 v132, v64, v65, v66
    v_min3_f32 v133, v64, v65, v66
    v_max3_f32 v134, v67, v68, v69
    v_min3_f32 v135, v67, v68, v69
    v_max3_f32 v132, v132, v70, v71
    v_min3_f32 v133, v133, v70, v71
    v_max3_f32 v134, v134, v72, v73
    v_min3_f32 v135, v135, v72, v73
    v_max3_f32 v132, v132, v74, v75
    v_min3_f32 v133, v133, v74, v75
    v_max3_f32 v134, v134, v76, v77
    v_min3_f32 v135, v135, v76, v77
    v_max3_f32 v132, v132, v78, v79
    v_min3_f32 v133, v133, v78, v79
    v_max3_f32 v134, v134, v80, v81
    v_min3_f32 v135, v135, v80, v81
    v_max3_f32 v132, v132, v82, v83
    v_min3_f32 v133, v133, v82, v83
    v_max_f32 v132, v132, v134
    v_min_f32 v133, v133, v135
    v_mul_f32 v134, v12, v132
    v_mul_f32 v136, v12, v133
    v_pk_fma_f32 v[144:145], v[64:65], v[12:13], v[136:137] op_sel_hi:[1,0,0] neg_lo:[1,0,0] neg_hi:[1,0,0]
    v_pk_fma_f32 v[64:65], v[64:65], v[12:13], v[134:135] op_sel_hi:[1,0,0] neg_lo:[0,0,1] neg_hi:[0,0,1]
    v_pk_fma_f32 v[146:147], v[66:67], v[12:13], v[136:137] op_sel_hi:[1,0,0] neg_lo:[1,0,0] neg_hi:[1,0,0]
    v_pk_fma_f32 v[66:67], v[66:67], v[12:13], v[134:135] op_sel_hi:[1,0,0] neg_lo:[0,0,1] neg_hi:[0,0,1]
    v_pk_fma_f32 v[148:149], v[68:69], v[12:13], v[136:137] op_sel_hi:[1,0,0] neg_lo:[1,0,0] neg_hi:[1,0,0]
    v_pk_fma_f32 v[68:69], v[68:69], v[12:13], v[134:135] op_sel_hi:[1,0,0] neg_lo:[0,0,1] neg_hi:[0,0,1]
    v_pk_fma_f32 v[150:151], v[70:71], v[12:13], v[136:137] op_sel_hi:[1,0,0] neg_lo:[1,0,0] neg_hi:[1,0,0]
    v_pk_fma_f32 v[70:71], v[70:71], v[12:13], v[134:135] op_sel_hi:[1,0,0] neg_lo:[0,0,1] neg_hi:[0,0,1]
    v_pk_fma_f32 v[152:153], v[72:73], v[12:13], v[136:137] op_sel_hi:[1,0,0] neg_lo:[1,0,0] neg_hi:[1,0,0]
    v_pk_fma_f32 v[72:73], v[72:73], v[12:13], v[134:135] op_sel_hi:[1,0,0] neg_lo:[0,0,1] neg_hi:[0,0,1]
    v_pk_fma_f32 v[154:155], v[74:75], v[12:13], v[136:137] op_sel_hi:[1,0,0] neg_lo:[1,0,0] neg_hi:[1,0,0]
    v_pk_fma_f32 v[74:75], v[74:75], v[12:13], v[134:135] op_sel_hi:[1,0,0] neg_lo:[0,0,1] neg_hi:[0,0,1]
    v_pk_fma_f32 v[156:157], v[76:77], v[12:13], v[136:137] op_sel_hi:[1,0,0] neg_lo:[1,0,0] neg_hi:[1,0,0]
    v_pk_fma_f32 v[76:77], v[76:77], v[12:13], v[134:135] op_sel_hi:[1,0,0] neg_lo:[0,0,1] neg_hi:[0,0,1]
    v_pk_fma_f32 v[158:159], v[78:79], v[12:13], v[136:137] op_sel_hi:[1,0,0] neg_lo:[1,0,0] neg_hi:[1,0,0]
    v_pk_fma_f32 v[78:79], v[78:79], v[12:13], v[134:135] op_sel_hi:[1,0,0] neg_lo:[0,0,1] neg_hi:[0,0,1]
    v_pk_fma_f32 v[160:161], v[80:81], v[12:13], v[136:137] op_sel_hi:[1,0,0] neg_lo:[1,0,0] neg_hi:[1,0,0]
    v_pk_fma_f32 v[80:81], v[80:81], v[12:13], v[134:135] op_sel_hi:[1,0,0] neg_lo:[0,0,1] neg_hi:[0,0,1]
    v_pk_fma_f32 v[162:163], v[82:83], v[12:13], v[136:137] op_sel_hi:[1,0,0] neg_lo:[1,0,0] neg_hi:[1,0,0]
    v_pk_fma_f32 v[82:83], v[82:83], v[12:13], v[134:135] op_sel_hi:[1,0,0] neg_lo:[0,0,1] neg_hi:[0,0,1]
    v_exp_f32 v64, v64
    v_exp_f32 v144, v144
    v_exp_f32 v65, v65
    v_exp_f32 v145, v145
    v_exp_f32 v66, v66
    v_exp_f32 v146, v146
    v_exp_f32 v67, v67
    v_exp_f32 v147, v147
    v_exp_f32 v68, v68
    v_exp_f32 v148, v148
    v_exp_f32 v69, v69
    v_exp_f32 v149, v149
    v_exp_f32 v70, v70
    v_exp_f32 v150, v150
    v_exp_f32 v71, v71
    v_exp_f32 v151, v151
    v_exp_f32 v72, v72
    v_exp_f32 v152, v152
    v_exp_f32 v73, v73
    v_exp_f32 v153, v153
    v_exp_f32 v74, v74
    v_exp_f32 v154, v154
    v_exp_f32 v75, v75
    v_exp_f32 v155, v155
    v_exp_f32 v76, v76
    v_exp_f32 v156, v156
    v_exp_f32 v77, v77
    v_exp_f32 v157, v157
    v_exp_f32 v78, v78
    v_exp_f32 v158, v158
    v_exp_f32 v79, v79
    v_exp_f32 v159, v159
    v_exp_f32 v80, v80
    v_exp_f32 v160, v160
    v_exp_f32 v81, v81
    v_exp_f32 v161, v161
    v_exp_f32 v82, v82
    v_exp_f32 v162, v162
    v_exp_f32 v83, v83
    v_exp_f32 v163, v163
    v_pk_add_f32 v[138:139], v[64:65], v[66:67]
    v_pk_add_f32 v[140:141], v[144:145], v[146:147]
    v_pk_add_f32 v[138:139], v[138:139], v[68:69]
    v_pk_add_f32 v[140:141], v[140:141], v[148:149]
    v_pk_add_f32 v[138:139], v[138:139], v[70:71]
    v_pk_add_f32 v[140:141], v[140:141], v[150:151]
    v_pk_add_f32 v[138:139], v[138:139], v[72:73]
    v_pk_add_f32 v[140:141], v[140:141], v[152:153]
    v_pk_add_f32 v[138:139], v[138:139], v[74:75]
    v_pk_add_f32 v[140:141], v[140:141], v[154:155]
    v_pk_add_f32 v[138:139], v[138:139], v[76:77]
    v_pk_add_f32 v[140:141], v[140:141], v[156:157]
    v_pk_add_f32 v[138:139], v[138:139], v[78:79]
    v_pk_add_f32 v[140:141], v[140:141], v[158:159]
    v_pk_add_f32 v[138:139], v[138:139], v[80:81]
    v_pk_add_f32 v[140:141], v[140:141], v[160:161]
    v_pk_add_f32 v[138:139], v[138:139], v[82:83]
    v_pk_add_f32 v[140:141], v[140:141], v[162:163]
    v_add_f32 v138, v138, v139
    v_add_f32 v140, v140, v141
    v_rcp_f32 v138, v138
    v_rcp_f32 v140, v140
    s_nop 0
    v_pk_mul_f32 v[64:65], v[64:65], v[138:139] op_sel_hi:[1,0]
    v_pk_mul_f32 v[144:145], v[144:145], v[140:141] op_sel_hi:[1,0]
    v_pk_mul_f32 v[66:67], v[66:67], v[138:139] op_sel_hi:[1,0]
    v_pk_mul_f32 v[146:147], v[146:147], v[140:141] op_sel_hi:[1,0]
    v_pk_mul_f32 v[68:69], v[68:69], v[138:139] op_sel_hi:[1,0]
    v_pk_mul_f32 v[148:149], v[148:149], v[140:141] op_sel_hi:[1,0]
    v_pk_mul_f32 v[70:71], v[70:71], v[138:139] op_sel_hi:[1,0]
    v_pk_mul_f32 v[150:151], v[150:151], v[140:141] op_sel_hi:[1,0]
    v_pk_mul_f32 v[72:73], v[72:73], v[138:139] op_sel_hi:[1,0]
    v_pk_mul_f32 v[152:153], v[152:153], v[140:141] op_sel_hi:[1,0]
    v_pk_mul_f32 v[74:75], v[74:75], v[138:139] op_sel_hi:[1,0]
    v_pk_mul_f32 v[154:155], v[154:155], v[140:141] op_sel_hi:[1,0]
    v_pk_mul_f32 v[76:77], v[76:77], v[138:139] op_sel_hi:[1,0]
    v_pk_mul_f32 v[156:157], v[156:157], v[140:141] op_sel_hi:[1,0]
    v_pk_mul_f32 v[78:79], v[78:79], v[138:139] op_sel_hi:[1,0]
    v_pk_mul_f32 v[158:159], v[158:159], v[140:141] op_sel_hi:[1,0]
    v_pk_mul_f32 v[80:81], v[80:81], v[138:139] op_sel_hi:[1,0]
    v_pk_mul_f32 v[160:161], v[160:161], v[140:141] op_sel_hi:[1,0]
    v_pk_mul_f32 v[82:83], v[82:83], v[138:139] op_sel_hi:[1,0]
    v_pk_mul_f32 v[162:163], v[162:163], v[140:141] op_sel_hi:[1,0]
    v_cvt_pk_bf16_f32 v16, v64, v65
    v_cvt_pk_bf16_f32 v26, v144, v145
    v_cvt_pk_bf16_f32 v17, v66, v67
    v_cvt_pk_bf16_f32 v27, v146, v147
    v_cvt_pk_bf16_f32 v18, v68, v69
    v_cvt_pk_bf16_f32 v28, v148, v149
    v_cvt_pk_bf16_f32 v19, v70, v71
    v_cvt_pk_bf16_f32 v29, v150, v151
    v_cvt_pk_bf16_f32 v20, v72, v73
    v_cvt_pk_bf16_f32 v30, v152, v153
    v_cvt_pk_bf16_f32 v21, v74, v75
    v_cvt_pk_bf16_f32 v31, v154, v155
    v_cvt_pk_bf16_f32 v22, v76, v77
    v_cvt_pk_bf16_f32 v32, v156, v157
    v_cvt_pk_bf16_f32 v23, v78, v79
    v_cvt_pk_bf16_f32 v33, v158, v159
    v_cvt_pk_bf16_f32 v24, v80, v81
    v_cvt_pk_bf16_f32 v34, v160, v161
    v_cvt_pk_bf16_f32 v25, v82, v83
    v_cvt_pk_bf16_f32 v35, v162, v163
    s_waitcnt vmcnt(0)
    v_mov_b32 v1, 1
    v_mov_b32 v2, 162560
    s_mov_b64 exec, 1
    ds_add_rtn_u32 v3, v2, v1
    s_waitcnt lgkmcnt(0)
    s_mov_b64 exec, -1
    v_readfirstlane_b32 s47, v3
    s_cmp_eq_u32 s47, 3
    s_cbranch_scc0 F_c0_nohf
    v_mov_b32 v1, s53
    v_mov_b32 v2, 0
    s_mov_b64 exec, 1
    buffer_store_dword v1, v2, s[16:19], s50 offen sc1
    s_mov_b64 exec, -1
F_c0_nohf:
    ds_write_b128 v9, v[16:19] offset:0
    ds_write_b128 v9, v[20:23] offset:16
    ds_write_b128 v9, v[24:27] offset:32
    ds_write_b128 v9, v[28:31] offset:48
    ds_write_b128 v9, v[32:35] offset:64
    v_max3_f32 v132, v84, v85, v86
    v_min3_f32 v133, v84, v85, v86
    v_max3_f32 v134, v87, v88, v89
    v_min3_f32 v135, v87, v88, v89
    v_max3_f32 v132, v132, v90, v91
    v_min3_f32 v133, v133, v90, v91
    v_max3_f32 v134, v134, v92, v93
    v_min3_f32 v135, v135, v92, v93
    v_max3_f32 v132, v132, v94, v95
    v_min3_f32 v133, v133, v94, v95
    v_max3_f32 v134, v134, v96, v97
    v_min3_f32 v135, v135, v96, v97
    v_max3_f32 v132, v132, v98, v99
    v_min3_f32 v133, v133, v98, v99
    v_max3_f32 v134, v134, v100, v101
    v_min3_f32 v135, v135, v100, v101
    v_max3_f32 v132, v132, v102, v103
    v_min3_f32 v133, v133, v102, v103
    v_max_f32 v132, v132, v134
    v_min_f32 v133, v133, v135
    v_mul_f32 v134, v12, v132
    v_mul_f32 v136, v12, v133
    v_pk_fma_f32 v[164:165], v[84:85], v[12:13], v[136:137] op_sel_hi:[1,0,0] neg_lo:[1,0,0] neg_hi:[1,0,0]
    v_pk_fma_f32 v[84:85], v[84:85], v[12:13], v[134:135] op_sel_hi:[1,0,0] neg_lo:[0,0,1] neg_hi:[0,0,1]
    v_pk_fma_f32 v[166:167], v[86:87], v[12:13], v[136:137] op_sel_hi:[1,0,0] neg_lo:[1,0,0] neg_hi:[1,0,0]
    v_pk_fma_f32 v[86:87], v[86:87], v[12:13], v[134:135] op_sel_hi:[1,0,0] neg_lo:[0,0,1] neg_hi:[0,0,1]
    v_pk_fma_f32 v[168:169], v[88:89], v[12:13], v[136:137] op_sel_hi:[1,0,0] neg_lo:[1,0,0] neg_hi:[1,0,0]
    v_pk_fma_f32 v[88:89], v[88:89], v[12:13], v[134:135] op_sel_hi:[1,0,0] neg_lo:[0,0,1] neg_hi:[0,0,1]
    v_pk_fma_f32 v[170:171], v[90:91], v[12:13], v[136:137] op_sel_hi:[1,0,0] neg_lo:[1,0,0] neg_hi:[1,0,0]
    v_pk_fma_f32 v[90:91], v[90:91], v[12:13], v[134:135] op_sel_hi:[1,0,0] neg_lo:[0,0,1] neg_hi:[0,0,1]
    v_pk_fma_f32 v[172:173], v[92:93], v[12:13], v[136:137] op_sel_hi:[1,0,0] neg_lo:[1,0,0] neg_hi:[1,0,0]
    v_pk_fma_f32 v[92:93], v[92:93], v[12:13], v[134:135] op_sel_hi:[1,0,0] neg_lo:[0,0,1] neg_hi:[0,0,1]
    v_pk_fma_f32 v[174:175], v[94:95], v[12:13], v[136:137] op_sel_hi:[1,0,0] neg_lo:[1,0,0] neg_hi:[1,0,0]
    v_pk_fma_f32 v[94:95], v[94:95], v[12:13], v[134:135] op_sel_hi:[1,0,0] neg_lo:[0,0,1] neg_hi:[0,0,1]
    v_pk_fma_f32 v[176:177], v[96:97], v[12:13], v[136:137] op_sel_hi:[1,0,0] neg_lo:[1,0,0] neg_hi:[1,0,0]
    v_pk_fma_f32 v[96:97], v[96:97], v[12:13], v[134:135] op_sel_hi:[1,0,0] neg_lo:[0,0,1] neg_hi:[0,0,1]
    v_pk_fma_f32 v[178:179], v[98:99], v[12:13], v[136:137] op_sel_hi:[1,0,0] neg_lo:[1,0,0] neg_hi:[1,0,0]
    v_pk_fma_f32 v[98:99], v[98:99], v[12:13], v[134:135] op_sel_hi:[1,0,0] neg_lo:[0,0,1] neg_hi:[0,0,1]
    v_pk_fma_f32 v[180:181], v[100:101], v[12:13], v[136:137] op_sel_hi:[1,0,0] neg_lo:[1,0,0] neg_hi:[1,0,0]
    v_pk_fma_f32 v[100:101], v[100:101], v[12:13], v[134:135] op_sel_hi:[1,0,0] neg_lo:[0,0,1] neg_hi:[0,0,1]
    v_pk_fma_f32 v[182:183], v[102:103], v[12:13], v[136:137] op_sel_hi:[1,0,0] neg_lo:[1,0,0] neg_hi:[1,0,0]
    v_pk_fma_f32 v[102:103], v[102:103], v[12:13], v[134:135] op_sel_hi:[1,0,0] neg_lo:[0,0,1] neg_hi:[0,0,1]
    v_exp_f32 v84, v84
    v_exp_f32 v164, v164
    v_exp_f32 v85, v85
    v_exp_f32 v165, v165
    v_exp_f32 v86, v86
    v_exp_f32 v166, v166
    v_exp_f32 v87, v87
    v_exp_f32 v167, v167
    v_exp_f32 v88, v88
    v_exp_f32 v168, v168
    v_exp_f32 v89, v89
    v_exp_f32 v169, v169
    v_exp_f32 v90, v90
    v_exp_f32 v170, v170
    v_exp_f32 v91, v91
    v_exp_f32 v171, v171
    v_exp_f32 v92, v92
    v_exp_f32 v172, v172
    v_exp_f32 v93, v93
    v_exp_f32 v173, v173
    v_exp_f32 v94, v94
    v_exp_f32 v174, v174
    v_exp_f32 v95, v95
    v_exp_f32 v175, v175
    v_exp_f32 v96, v96
    v_exp_f32 v176, v176
    v_exp_f32 v97, v97
    v_exp_f32 v177, v177
    v_exp_f32 v98, v98
    v_exp_f32 v178, v178
    v_exp_f32 v99, v99
    v_exp_f32 v179, v179
    v_exp_f32 v100, v100
    v_exp_f32 v180, v180
    v_exp_f32 v101, v101
    v_exp_f32 v181, v181
    v_exp_f32 v102, v102
    v_exp_f32 v182, v182
    v_exp_f32 v103, v103
    v_exp_f32 v183, v183
    v_pk_add_f32 v[138:139], v[84:85], v[86:87]
    v_pk_add_f32 v[140:141], v[164:165], v[166:167]
    v_pk_add_f32 v[138:139], v[138:139], v[88:89]
    v_pk_add_f32 v[140:141], v[140:141], v[168:169]
    v_pk_add_f32 v[138:139], v[138:139], v[90:91]
    v_pk_add_f32 v[140:141], v[140:141], v[170:171]
    v_pk_add_f32 v[138:139], v[138:139], v[92:93]
    v_pk_add_f32 v[140:141], v[140:141], v[172:173]
    v_pk_add_f32 v[138:139], v[138:139], v[94:95]
    v_pk_add_f32 v[140:141], v[140:141], v[174:175]
    v_pk_add_f32 v[138:139], v[138:139], v[96:97]
    v_pk_add_f32 v[140:141], v[140:141], v[176:177]
    v_pk_add_f32 v[138:139], v[138:139], v[98:99]
    v_pk_add_f32 v[140:141], v[140:141], v[178:179]
    v_pk_add_f32 v[138:139], v[138:139], v[100:101]
    v_pk_add_f32 v[140:141], v[140:141], v[180:181]
    v_pk_add_f32 v[138:139], v[138:139], v[102:103]
    v_pk_add_f32 v[140:141], v[140:141], v[182:183]
    v_add_f32 v138, v138, v139
    v_add_f32 v140, v140, v141
    v_rcp_f32 v138, v138
    v_rcp_f32 v140, v140
    s_nop 0
    v_pk_mul_f32 v[84:85], v[84:85], v[138:139] op_sel_hi:[1,0]
    v_pk_mul_f32 v[164:165], v[164:165], v[140:141] op_sel_hi:[1,0]
    v_pk_mul_f32 v[86:87], v[86:87], v[138:139] op_sel_hi:[1,0]
    v_pk_mul_f32 v[166:167], v[166:167], v[140:141] op_sel_hi:[1,0]
    v_pk_mul_f32 v[88:89], v[88:89], v[138:139] op_sel_hi:[1,0]
    v_pk_mul_f32 v[168:169], v[168:169], v[140:141] op_sel_hi:[1,0]
    v_pk_mul_f32 v[90:91], v[90:91], v[138:139] op_sel_hi:[1,0]
    v_pk_mul_f32 v[170:171], v[170:171], v[140:141] op_sel_hi:[1,0]
    v_pk_mul_f32 v[92:93], v[92:93], v[138:139] op_sel_hi:[1,0]
    v_pk_mul_f32 v[172:173], v[172:173], v[140:141] op_sel_hi:[1,0]
    v_pk_mul_f32 v[94:95], v[94:95], v[138:139] op_sel_hi:[1,0]
    v_pk_mul_f32 v[174:175], v[174:175], v[140:141] op_sel_hi:[1,0]
    v_pk_mul_f32 v[96:97], v[96:97], v[138:139] op_sel_hi:[1,0]
    v_pk_mul_f32 v[176:177], v[176:177], v[140:141] op_sel_hi:[1,0]
    v_pk_mul_f32 v[98:99], v[98:99], v[138:139] op_sel_hi:[1,0]
    v_pk_mul_f32 v[178:179], v[178:179], v[140:141] op_sel_hi:[1,0]
    v_pk_mul_f32 v[100:101], v[100:101], v[138:139] op_sel_hi:[1,0]
    v_pk_mul_f32 v[180:181], v[180:181], v[140:141] op_sel_hi:[1,0]
    v_pk_mul_f32 v[102:103], v[102:103], v[138:139] op_sel_hi:[1,0]
    v_pk_mul_f32 v[182:183], v[182:183], v[140:141] op_sel_hi:[1,0]
    v_cvt_pk_bf16_f32 v36, v84, v85
    v_cvt_pk_bf16_f32 v46, v164, v165
    v_cvt_pk_bf16_f32 v37, v86, v87
    v_cvt_pk_bf16_f32 v47, v166, v167
    v_cvt_pk_bf16_f32 v38, v88, v89
    v_cvt_pk_bf16_f32 v48, v168, v169
    v_cvt_pk_bf16_f32 v39, v90, v91
    v_cvt_pk_bf16_f32 v49, v170, v171
    v_cvt_pk_bf16_f32 v40, v92, v93
    v_cvt_pk_bf16_f32 v50, v172, v173
    v_cvt_pk_bf16_f32 v41, v94, v95
    v_cvt_pk_bf16_f32 v51, v174, v175
    v_cvt_pk_bf16_f32 v42, v96, v97
    v_cvt_pk_bf16_f32 v52, v176, v177
    v_cvt_pk_bf16_f32 v43, v98, v99
    v_cvt_pk_bf16_f32 v53, v178, v179
    v_cvt_pk_bf16_f32 v44, v100, v101
    v_cvt_pk_bf16_f32 v54, v180, v181
    v_cvt_pk_bf16_f32 v45, v102, v103
    v_cvt_pk_bf16_f32 v55, v182, v183
    ds_write_b128 v9, v[36:39] offset:80
    ds_write_b128 v9, v[40:43] offset:96
    ds_write_b128 v9, v[44:47] offset:112
    ds_write_b128 v9, v[48:51] offset:128
    ds_write_b128 v9, v[52:55] offset:144
    v_mov_b32 v1, 1
    v_mov_b32 v2, 162564
    s_mov_b64 exec, 1
    ds_add_u32 v2, v1
    s_mov_b64 exec, -1
    v_mov_b32 v2, 162564
    s_mov_b32 s48, 0
spin_12:
    ds_read_b32 v3, v2
    s_add_u32 s48, s48, 1
    s_waitcnt lgkmcnt(0)
    v_readfirstlane_b32 s47, v3
    s_cmp_ge_u32 s48, 262144
    s_cbranch_scc1 spin_12_x
    s_cmp_lt_u32 s47, 4
    s_cbranch_scc1 spin_12
spin_12_x:
    s_cmp_eq_u32 s31, 0
    s_cbranch_scc0 ef_13
    v_mov_b32 v1, s53
    v_mov_b32 v2, 0
    s_mov_b64 exec, 1
    buffer_store_dword v1, v2, s[16:19], s51 offen sc1
    s_mov_b64 exec, -1
ef_13:
    ds_read_b64_tr_b16 v[64:65], v61 offset:0
    ds_read_b64_tr_b16 v[68:69], v61 offset:40
    ds_read_b64_tr_b16 v[72:73], v62 offset:0
    ds_read_b64_tr_b16 v[66:67], v61 offset:2240
    ds_read_b64_tr_b16 v[70:71], v61 offset:2280
    ds_read_b64_tr_b16 v[74:75], v62 offset:2240
    ds_read_b64_tr_b16 v[76:77], v61 offset:8960
    ds_read_b64_tr_b16 v[80:81], v61 offset:9000
    ds_read_b64_tr_b16 v[84:85], v62 offset:8960
    ds_read_b64_tr_b16 v[78:79], v61 offset:11200
    ds_read_b64_tr_b16 v[82:83], v61 offset:11240
    ds_read_b64_tr_b16 v[86:87], v62 offset:11200
    ds_read_b64_tr_b16 v[88:89], v61 offset:17920
    ds_read_b64_tr_b16 v[92:93], v61 offset:17960
    ds_read_b64_tr_b16 v[96:97], v62 offset:17920
    ds_read_b64_tr_b16 v[90:91], v61 offset:20160
    ds_read_b64_tr_b16 v[94:95], v61 offset:20200
    ds_read_b64_tr_b16 v[98:99], v62 offset:20160
    s_waitcnt lgkmcnt(12)
    v_mfma_f32_32x32x16_bf16 v[160:175], v[64:67], v[72:75], 0
    v_mfma_f32_32x32x16_bf16 v[176:191], v[68:71], v[72:75], 0
    ds_read_b64_tr_b16 v[100:101], v61 offset:26880
    ds_read_b64_tr_b16 v[104:105], v61 offset:26920
    ds_read_b64_tr_b16 v[108:109], v62 offset:26880
    ds_read_b64_tr_b16 v[102:103], v61 offset:29120
    ds_read_b64_tr_b16 v[106:107], v61 offset:29160
    ds_read_b64_tr_b16 v[110:111], v62 offset:29120
    s_waitcnt lgkmcnt(12)
    v_mfma_f32_32x32x16_bf16 v[160:175], v[76:79], v[84:87], v[160:175]
    v_mfma_f32_32x32x16_bf16 v[176:191], v[80:83], v[84:87], v[176:191]
    ds_read_b64_tr_b16 v[112:113], v61 offset:35840
    ds_read_b64_tr_b16 v[116:117], v61 offset:35880
    ds_read_b64_tr_b16 v[120:121], v62 offset:35840
    ds_read_b64_tr_b16 v[114:115], v61 offset:38080
    ds_read_b64_tr_b16 v[118:119], v61 offset:38120
    ds_read_b64_tr_b16 v[122:123], v62 offset:38080
    s_waitcnt lgkmcnt(12)
    v_mfma_f32_32x32x16_bf16 v[160:175], v[88:91], v[96:99], v[160:175]
    v_mfma_f32_32x32x16_bf16 v[176:191], v[92:95], v[96:99], v[176:191]
    ds_read_b64_tr_b16 v[124:125], v61 offset:44800
    ds_read_b64_tr_b16 v[128:129], v61 offset:44840
    ds_read_b64_tr_b16 v[132:133], v62 offset:44800
    ds_read_b64_tr_b16 v[126:127], v61 offset:47040
    ds_read_b64_tr_b16 v[130:131], v61 offset:47080
    ds_read_b64_tr_b16 v[134:135], v62 offset:47040
    s_waitcnt lgkmcnt(12)
    v_mfma_f32_32x32x16_bf16 v[160:175], v[100:103], v[108:111], v[160:175]
    v_mfma_f32_32x32x16_bf16 v[176:191], v[104:107], v[108:111], v[176:191]
    ds_read_b64_tr_b16 v[136:137], v61 offset:53760
    ds_read_b64_tr_b16 v[140:141], v61 offset:53800
    ds_read_b64_tr_b16 v[144:145], v62 offset:53760
    ds_read_b64_tr_b16 v[138:139], v61 offset:56000
    ds_read_b64_tr_b16 v[142:143], v61 offset:56040
    ds_read_b64_tr_b16 v[146:147], v62 offset:56000
    s_waitcnt lgkmcnt(12)
    v_mfma_f32_32x32x16_bf16 v[160:175], v[112:115], v[120:123], v[160:175]
    v_mfma_f32_32x32x16_bf16 v[176:191], v[116:119], v[120:123], v[176:191]
    ds_read_b64_tr_b16 v[148:149], v61 offset:62720
    ds_read_b64_tr_b16 v[152:153], v61 offset:62760
    ds_read_b64_tr_b16 v[156:157], v62 offset:62720
    ds_read_b64_tr_b16 v[150:151], v61 offset:64960
    ds_read_b64_tr_b16 v[154:155], v61 offset:65000
    ds_read_b64_tr_b16 v[158:159], v62 offset:64960
    s_waitcnt lgkmcnt(12)
    v_mfma_f32_32x32x16_bf16 v[160:175], v[124:127], v[132:135], v[160:175]
    v_mfma_f32_32x32x16_bf16 v[176:191], v[128:131], v[132:135], v[176:191]
    s_waitcnt lgkmcnt(6)
    v_mfma_f32_32x32x16_bf16 v[160:175], v[136:139], v[144:147], v[160:175]
    v_mfma_f32_32x32x16_bf16 v[176:191], v[140:143], v[144:147], v[176:191]
    s_waitcnt lgkmcnt(0)
    v_mfma_f32_32x32x16_bf16 v[160:175], v[148:151], v[156:159], v[160:175]
    v_mfma_f32_32x32x16_bf16 v[176:191], v[152:155], v[156:159], v[176:191]
    s_mov_b32 exec_lo, 0x1fffff
    s_mov_b32 exec_hi, 0x1fffff
    s_nop 7
    s_nop 2
    v_cvt_pk_bf16_f32 v200, v160, v161
    v_cvt_pk_bf16_f32 v201, v162, v163
    v_cvt_pk_bf16_f32 v202, v164, v165
    v_cvt_pk_bf16_f32 v203, v166, v167
    v_cvt_pk_bf16_f32 v208, v168, v169
    v_cvt_pk_bf16_f32 v209, v170, v171
    buffer_store_dwordx4 v[200:203], v63, s[16:19], s56 offen offset:0 sc1
    v_cvt_pk_bf16_f32 v204, v176, v177
    v_cvt_pk_bf16_f32 v205, v178, v179
    v_cvt_pk_bf16_f32 v206, v180, v181
    v_cvt_pk_bf16_f32 v207, v182, v183
    v_cvt_pk_bf16_f32 v210, v184, v185
    v_cvt_pk_bf16_f32 v211, v186, v187
    buffer_store_dwordx4 v[204:207], v63, s[16:19], s56 offen offset:672 sc1
    s_mov_b32 exec_hi, 0
    buffer_store_dwordx4 v[208:211], v63, s[16:19], s56 offen offset:1344 sc1
    s_mov_b64 exec, -1
    s_branch F_fin
F_c0_it2:
    s_cmp_eq_u32 s40, 8
    s_cbranch_scc1 F_c0_it0
    s_cmp_eq_u32 s40, 4
    s_cbranch_scc1 F_c0_itc
    s_cmp_eq_u32 s40, 1
    s_cbranch_scc1 F_c0_it1
    v_mov_b32 v13, 162592
    ds_read_b32 v12, v13
    s_waitcnt vmcnt(0) lgkmcnt(0)
    s_barrier
    v_readfirstlane_b32 s53, v12
    s_cmp_eq_u32 s31, 0
    s_cbranch_scc0 F_c0_it2r
    v_mov_b32 v13, 0
    s_mov_b64 exec, 1
    buffer_store_dword v12, v13, s[16:19], s54 offen sc1
    s_mov_b64 exec, -1
    s_branch F_c0_it2r
F_c0_it0:
    s_waitcnt vmcnt(0)
    v_lshlrev_b32 v13, 4, v60
    buffer_store_dwordx4 v[16:19], v13, s[16:19], s56 offen sc1
    v_cmp_gt_u32 vcc, 41, v60
    s_mov_b64 exec, vcc
    buffer_store_dwordx4 v[16:19], v13, s[16:19], s56 offen offset:1024 sc1
    s_mov_b64 exec, -1
F_c0_itx:
    s_waitcnt lgkmcnt(0)
    s_barrier
    s_branch F_c0_it2r
F_c0_it1:
    s_branch F_c0_itx
F_c0_itc:
    s_getpc_b64 s[46:47]
F_c0_pc:
    s_sub_u32 s46, s46, F_c0_pc-parallel_sum__linear_kernel_hedgehog__dense_activation_squared_relu__prompt_kernel
    s_subb_u32 s47, s47, 0
    s_lshr_b32 s44, s2, 3
    s_lshl_b32 s44, s44, 2
    s_add_u32 s44, s44, s31
    s_lshl_b32 s44, s44, 9
    v_and_b32 v13, 3, v60
    v_lshl_add_u32 v13, v13, 7, s44
    v_min_u32 v13, F_end-parallel_sum__linear_kernel_hedgehog__dense_activation_squared_relu__prompt_kernel, v13
    global_load_dword v79, v13, s[46:47]
    s_branch F_c0_itx
F_c1:
    s_barrier
    ds_read_b128 v[80:83], v1
    ds_read_b64_tr_b16 v[84:85], v5 offset:0
    ds_read_b64_tr_b16 v[86:87], v5 offset:768
    ds_read_b64_tr_b16 v[88:89], v5 offset:32
    ds_read_b64_tr_b16 v[90:91], v5 offset:800
    ds_read_b64_tr_b16 v[92:93], v5 offset:64
    ds_read_b64_tr_b16 v[94:95], v5 offset:832
    ds_read_b64_tr_b16 v[96:97], v6 offset:0
    ds_read_b64_tr_b16 v[98:99], v6 offset:1024
    ds_read_b64_tr_b16 v[100:101], v7 offset:0
    ds_read_b64_tr_b16 v[102:103], v7 offset:1024
    ds_read_b64_tr_b16 v[104:105], v8 offset:0
    ds_read_b64_tr_b16 v[106:107], v8 offset:1024
    ds_read_b64_tr_b16 v[108:109], v9 offset:0
    ds_read_b64_tr_b16 v[110:111], v9 offset:1024
F_c1_loop:
    s_waitcnt lgkmcnt(0)
    v_mfma_f32_32x32x16_bf16 v[144:159], v[84:87], v[80:83], v[144:159]
    ds_read_b128 v[112:115], v2
    ds_read_b64_tr_b16 v[116:117], v5 offset:3072
    ds_read_b64_tr_b16 v[118:119], v5 offset:3840
    v_mfma_f32_32x32x16_bf16 v[160:175], v[88:91], v[80:83], v[160:175]
    ds_read_b64_tr_b16 v[120:121], v5 offset:3104
    ds_read_b64_tr_b16 v[122:123], v5 offset:3872
    ds_read_b64_tr_b16 v[124:125], v5 offset:3136
    v_mfma_f32_32x32x16_bf16 v[176:191], v[92:95], v[80:83], v[176:191]
    ds_read_b64_tr_b16 v[126:127], v5 offset:3904
    ds_read_b64_tr_b16 v[128:129], v6 offset:4096
    ds_read_b64_tr_b16 v[130:131], v6 offset:5120
    v_mfma_f32_32x32x16_bf16 v[192:207], v[96:99], v[80:83], v[192:207]
    ds_read_b64_tr_b16 v[132:133], v7 offset:4096
    ds_read_b64_tr_b16 v[134:135], v7 offset:5120
    ds_read_b64_tr_b16 v[136:137], v8 offset:4096
    v_mfma_f32_32x32x16_bf16 v[208:223], v[100:103], v[80:83], v[208:223]
    ds_read_b64_tr_b16 v[138:139], v8 offset:5120
    ds_read_b64_tr_b16 v[140:141], v9 offset:4096
    ds_read_b64_tr_b16 v[142:143], v9 offset:5120
    v_mfma_f32_32x32x16_bf16 v[224:239], v[104:107], v[80:83], v[224:239]
    v_mfma_f32_32x32x16_bf16 v[240:255], v[108:111], v[80:83], v[240:255]
    s_waitcnt lgkmcnt(0)
    v_mfma_f32_32x32x16_bf16 v[144:159], v[116:119], v[112:115], v[144:159]
    ds_read_b128 v[80:83], v3
    ds_read_b64_tr_b16 v[84:85], v5 offset:6144
    ds_read_b64_tr_b16 v[86:87], v5 offset:6912
    v_mfma_f32_32x32x16_bf16 v[160:175], v[120:123], v[112:115], v[160:175]
    ds_read_b64_tr_b16 v[88:89], v5 offset:6176
    ds_read_b64_tr_b16 v[90:91], v5 offset:6944
    ds_read_b64_tr_b16 v[92:93], v5 offset:6208
    v_mfma_f32_32x32x16_bf16 v[176:191], v[124:127], v[112:115], v[176:191]
    ds_read_b64_tr_b16 v[94:95], v5 offset:6976
    ds_read_b64_tr_b16 v[96:97], v6 offset:8192
    ds_read_b64_tr_b16 v[98:99], v6 offset:9216
    v_mfma_f32_32x32x16_bf16 v[192:207], v[128:131], v[112:115], v[192:207]
    ds_read_b64_tr_b16 v[100:101], v7 offset:8192
    ds_read_b64_tr_b16 v[102:103], v7 offset:9216
    ds_read_b64_tr_b16 v[104:105], v8 offset:8192
    v_mfma_f32_32x32x16_bf16 v[208:223], v[132:135], v[112:115], v[208:223]
    ds_read_b64_tr_b16 v[106:107], v8 offset:9216
    ds_read_b64_tr_b16 v[108:109], v9 offset:8192
    ds_read_b64_tr_b16 v[110:111], v9 offset:9216
    v_mfma_f32_32x32x16_bf16 v[224:239], v[136:139], v[112:115], v[224:239]
    v_mfma_f32_32x32x16_bf16 v[240:255], v[140:143], v[112:115], v[240:255]
    s_waitcnt lgkmcnt(0)
    v_mfma_f32_32x32x16_bf16 v[144:159], v[84:87], v[80:83], v[144:159]
    ds_read_b128 v[112:115], v4
    ds_read_b64_tr_b16 v[116:117], v5 offset:9216
    ds_read_b64_tr_b16 v[118:119], v5 offset:9984
    v_mfma_f32_32x32x16_bf16 v[160:175], v[88:91], v[80:83], v[160:175]
    ds_read_b64_tr_b16 v[120:121], v5 offset:9248
    ds_read_b64_tr_b16 v[122:123], v5 offset:10016
    ds_read_b64_tr_b16 v[124:125], v5 offset:9280
    v_mfma_f32_32x32x16_bf16 v[176:191], v[92:95], v[80:83], v[176:191]
    ds_read_b64_tr_b16 v[126:127], v5 offset:10048
    ds_read_b64_tr_b16 v[128:129], v6 offset:12288
    ds_read_b64_tr_b16 v[130:131], v6 offset:13312
    v_mfma_f32_32x32x16_bf16 v[192:207], v[96:99], v[80:83], v[192:207]
    ds_read_b64_tr_b16 v[132:133], v7 offset:12288
    ds_read_b64_tr_b16 v[134:135], v7 offset:13312
    ds_read_b64_tr_b16 v[136:137], v8 offset:12288
    v_mfma_f32_32x32x16_bf16 v[208:223], v[100:103], v[80:83], v[208:223]
    ds_read_b64_tr_b16 v[138:139], v8 offset:13312
    ds_read_b64_tr_b16 v[140:141], v9 offset:12288
    ds_read_b64_tr_b16 v[142:143], v9 offset:13312
    v_mfma_f32_32x32x16_bf16 v[224:239], v[104:107], v[80:83], v[224:239]
    s_cmp_eq_u32 s42, 2
    s_cselect_b32 s41, -90112, s45
    s_add_u32 s42, s42, 1
    s_cmp_eq_u32 s42, 3
    s_cselect_b32 s42, 0, s42
    s_bitcmp1_b32 s57, s40
    v_mfma_f32_32x32x16_bf16 v[240:255], v[108:111], v[80:83], v[240:255]
    s_cbranch_scc1 F_c1_it2
    s_waitcnt lgkmcnt(0)
    s_barrier
F_c1_it2r:
    v_mfma_f32_32x32x16_bf16 v[144:159], v[116:119], v[112:115], v[144:159]
    v_add_u32 v1, s41, v1
    v_add_u32 v5, s41, v5
    ds_read_b128 v[80:83], v1
    ds_read_b64_tr_b16 v[84:85], v5 offset:0
    ds_read_b64_tr_b16 v[86:87], v5 offset:768
    v_mfma_f32_32x32x16_bf16 v[160:175], v[120:123], v[112:115], v[160:175]
    v_add_u32 v6, s41, v6
    v_add_u32 v7, s41, v7
    v_add_u32 v8, s41, v8
    v_add_u32 v9, s41, v9
    ds_read_b64_tr_b16 v[88:89], v5 offset:32
    ds_read_b64_tr_b16 v[90:91], v5 offset:800
    ds_read_b64_tr_b16 v[92:93], v5 offset:64
    v_mfma_f32_32x32x16_bf16 v[176:191], v[124:127], v[112:115], v[176:191]
    v_add_u32 v2, s41, v2
    v_add_u32 v3, s41, v3
    v_add_u32 v4, s41, v4
    ds_read_b64_tr_b16 v[94:95], v5 offset:832
    ds_read_b64_tr_b16 v[96:97], v6 offset:0
    ds_read_b64_tr_b16 v[98:99], v6 offset:1024
    v_mfma_f32_32x32x16_bf16 v[192:207], v[128:131], v[112:115], v[192:207]
    ds_read_b64_tr_b16 v[100:101], v7 offset:0
    ds_read_b64_tr_b16 v[102:103], v7 offset:1024
    ds_read_b64_tr_b16 v[104:105], v8 offset:0
    v_mfma_f32_32x32x16_bf16 v[208:223], v[132:135], v[112:115], v[208:223]
    ds_read_b64_tr_b16 v[106:107], v8 offset:1024
    ds_read_b64_tr_b16 v[108:109], v9 offset:0
    ds_read_b64_tr_b16 v[110:111], v9 offset:1024
    v_mfma_f32_32x32x16_bf16 v[224:239], v[136:139], v[112:115], v[224:239]
    s_add_u32 s40, s40, 1
    s_cmp_lt_u32 s40, 10
    v_mfma_f32_32x32x16_bf16 v[240:255], v[140:143], v[112:115], v[240:255]
    s_cbranch_scc1 F_c1_loop
    s_setprio 3
    s_waitcnt lgkmcnt(0)
    v_mfma_f32_32x32x16_bf16 v[192:207], v[96:99], v[80:83], v[192:207]
    ds_read_b32 v10, v10
    ds_read_b64_tr_b16 v[16:17], v11 offset:0
    ds_read_b64_tr_b16 v[18:19], v11 offset:384
    ds_read_b64_tr_b16 v[20:21], v11 offset:32
    v_mfma_f32_32x32x16_bf16 v[208:223], v[100:103], v[80:83], v[208:223]
    ds_read_b64_tr_b16 v[22:23], v11 offset:416
    ds_read_b64_tr_b16 v[24:25], v11 offset:768
    ds_read_b64_tr_b16 v[26:27], v11 offset:1152
    ds_read_b64_tr_b16 v[28:29], v11 offset:800
    v_mfma_f32_32x32x16_bf16 v[224:239], v[104:107], v[80:83], v[224:239]
    ds_read_b64_tr_b16 v[30:31], v11 offset:1184
    ds_read_b64_tr_b16 v[32:33], v11 offset:1600
    ds_read_b64_tr_b16 v[34:35], v11 offset:1984
    ds_read_b64_tr_b16 v[36:37], v11 offset:1536
    v_mfma_f32_32x32x16_bf16 v[240:255], v[108:111], v[80:83], v[240:255]
    ds_read_b64_tr_b16 v[38:39], v11 offset:1920
    ds_read_b64_tr_b16 v[40:41], v11 offset:1568
    ds_read_b64_tr_b16 v[42:43], v11 offset:1952
    ds_read_b64_tr_b16 v[44:45], v11 offset:2368
    v_mfma_f32_32x32x16_bf16 v[144:159], v[84:87], v[80:83], v[144:159]
    ds_read_b64_tr_b16 v[46:47], v11 offset:2752
    ds_read_b64_tr_b16 v[48:49], v11 offset:2336
    ds_read_b64_tr_b16 v[50:51], v11 offset:2720
    ds_read_b64_tr_b16 v[52:53], v11 offset:3136
    v_mfma_f32_32x32x16_bf16 v[160:175], v[88:91], v[80:83], v[160:175]
    ds_read_b64_tr_b16 v[54:55], v11 offset:3520
    ds_read_b64_tr_b16 v[56:57], v11 offset:3104
    ds_read_b64_tr_b16 v[58:59], v11 offset:3488
    v_mfma_f32_32x32x16_bf16 v[176:191], v[92:95], v[80:83], v[176:191]
    s_waitcnt lgkmcnt(15)
    v_mul_f32 v12, 0x3fb8aa3b, v10
    v_mul_f32 v14, v10, v10
    v_max_f32 v192, 0, v192
    v_max_f32 v193, 0, v193
    v_max_f32 v194, 0, v194
    v_max_f32 v195, 0, v195
    v_max_f32 v196, 0, v196
    v_max_f32 v197, 0, v197
    v_max_f32 v198, 0, v198
    v_max_f32 v199, 0, v199
    v_pk_mul_f32 v[136:137], v[192:193], v[14:15] op_sel_hi:[1,0]
    v_pk_mul_f32 v[138:139], v[194:195], v[14:15] op_sel_hi:[1,0]
    v_pk_mul_f32 v[140:141], v[196:197], v[14:15] op_sel_hi:[1,0]
    v_pk_mul_f32 v[142:143], v[198:199], v[14:15] op_sel_hi:[1,0]
    v_pk_mul_f32 v[192:193], v[136:137], v[192:193]
    v_pk_mul_f32 v[194:195], v[138:139], v[194:195]
    v_pk_mul_f32 v[196:197], v[140:141], v[196:197]
    v_pk_mul_f32 v[198:199], v[142:143], v[198:199]
    v_cvt_pk_bf16_f32 v192, v192, v193
    v_cvt_pk_bf16_f32 v193, v194, v195
    v_cvt_pk_bf16_f32 v194, v196, v197
    v_cvt_pk_bf16_f32 v195, v198, v199
    buffer_store_dwordx4 v[192:195], v15, s[16:19], s43 offen offset:0 sc1
    s_waitcnt lgkmcnt(0)
    s_barrier
    v_max_f32 v200, 0, v200
    v_max_f32 v201, 0, v201
    v_max_f32 v202, 0, v202
    v_max_f32 v203, 0, v203
    v_max_f32 v204, 0, v204
    v_max_f32 v205, 0, v205
    v_max_f32 v206, 0, v206
    v_max_f32 v207, 0, v207
    v_pk_mul_f32 v[136:137], v[200:201], v[14:15] op_sel_hi:[1,0]
    v_pk_mul_f32 v[138:139], v[202:203], v[14:15] op_sel_hi:[1,0]
    v_pk_mul_f32 v[140:141], v[204:205], v[14:15] op_sel_hi:[1,0]
    v_pk_mul_f32 v[142:143], v[206:207], v[14:15] op_sel_hi:[1,0]
    v_pk_mul_f32 v[200:201], v[136:137], v[200:201]
    v_pk_mul_f32 v[202:203], v[138:139], v[202:203]
    v_pk_mul_f32 v[204:205], v[140:141], v[204:205]
    v_pk_mul_f32 v[206:207], v[142:143], v[206:207]
    v_cvt_pk_bf16_f32 v200, v200, v201
    v_cvt_pk_bf16_f32 v201, v202, v203
    v_cvt_pk_bf16_f32 v202, v204, v205
    v_cvt_pk_bf16_f32 v203, v206, v207
    buffer_store_dwordx4 v[200:203], v15, s[16:19], s43 offen offset:512 sc1
    v_max_f32 v208, 0, v208
    v_max_f32 v209, 0, v209
    v_max_f32 v210, 0, v210
    v_max_f32 v211, 0, v211
    v_max_f32 v212, 0, v212
    v_max_f32 v213, 0, v213
    v_max_f32 v214, 0, v214
    v_max_f32 v215, 0, v215
    v_pk_mul_f32 v[136:137], v[208:209], v[14:15] op_sel_hi:[1,0]
    v_pk_mul_f32 v[138:139], v[210:211], v[14:15] op_sel_hi:[1,0]
    v_pk_mul_f32 v[140:141], v[212:213], v[14:15] op_sel_hi:[1,0]
    v_pk_mul_f32 v[142:143], v[214:215], v[14:15] op_sel_hi:[1,0]
    v_pk_mul_f32 v[208:209], v[136:137], v[208:209]
    v_pk_mul_f32 v[210:211], v[138:139], v[210:211]
    v_pk_mul_f32 v[212:213], v[140:141], v[212:213]
    v_pk_mul_f32 v[214:215], v[142:143], v[214:215]
    v_cvt_pk_bf16_f32 v208, v208, v209
    v_cvt_pk_bf16_f32 v209, v210, v211
    v_cvt_pk_bf16_f32 v210, v212, v213
    v_cvt_pk_bf16_f32 v211, v214, v215
    buffer_store_dwordx4 v[208:211], v15, s[16:19], s43 offen offset:1024 sc1
    v_max_f32 v216, 0, v216
    v_max_f32 v217, 0, v217
    v_max_f32 v218, 0, v218
    v_max_f32 v219, 0, v219
    v_max_f32 v220, 0, v220
    v_max_f32 v221, 0, v221
    v_max_f32 v222, 0, v222
    v_max_f32 v223, 0, v223
    v_pk_mul_f32 v[136:137], v[216:217], v[14:15] op_sel_hi:[1,0]
    v_pk_mul_f32 v[138:139], v[218:219], v[14:15] op_sel_hi:[1,0]
    v_pk_mul_f32 v[140:141], v[220:221], v[14:15] op_sel_hi:[1,0]
    v_pk_mul_f32 v[142:143], v[222:223], v[14:15] op_sel_hi:[1,0]
    v_pk_mul_f32 v[216:217], v[136:137], v[216:217]
    v_pk_mul_f32 v[218:219], v[138:139], v[218:219]
    v_pk_mul_f32 v[220:221], v[140:141], v[220:221]
    v_pk_mul_f32 v[222:223], v[142:143], v[222:223]
    v_cvt_pk_bf16_f32 v216, v216, v217
    v_cvt_pk_bf16_f32 v217, v218, v219
    v_cvt_pk_bf16_f32 v218, v220, v221
    v_cvt_pk_bf16_f32 v219, v222, v223
    buffer_store_dwordx4 v[216:219], v15, s[16:19], s43 offen offset:1536 sc1
    v_max_f32 v224, 0, v224
    v_max_f32 v225, 0, v225
    v_max_f32 v226, 0, v226
    v_max_f32 v227, 0, v227
    v_max_f32 v228, 0, v228
    v_max_f32 v229, 0, v229
    v_max_f32 v230, 0, v230
    v_max_f32 v231, 0, v231
    v_pk_mul_f32 v[136:137], v[224:225], v[14:15] op_sel_hi:[1,0]
    v_pk_mul_f32 v[138:139], v[226:227], v[14:15] op_sel_hi:[1,0]
    v_pk_mul_f32 v[140:141], v[228:229], v[14:15] op_sel_hi:[1,0]
    v_pk_mul_f32 v[142:143], v[230:231], v[14:15] op_sel_hi:[1,0]
    v_pk_mul_f32 v[224:225], v[136:137], v[224:225]
    v_pk_mul_f32 v[226:227], v[138:139], v[226:227]
    v_pk_mul_f32 v[228:229], v[140:141], v[228:229]
    v_pk_mul_f32 v[230:231], v[142:143], v[230:231]
    v_cvt_pk_bf16_f32 v224, v224, v225
    v_cvt_pk_bf16_f32 v225, v226, v227
    v_cvt_pk_bf16_f32 v226, v228, v229
    v_cvt_pk_bf16_f32 v227, v230, v231
    buffer_store_dwordx4 v[224:227], v15, s[16:19], s43 offen offset:2048 sc1
    v_max_f32 v232, 0, v232
    v_max_f32 v233, 0, v233
    v_max_f32 v234, 0, v234
    v_max_f32 v235, 0, v235
    v_max_f32 v236, 0, v236
    v_max_f32 v237, 0, v237
    v_max_f32 v238, 0, v238
    v_max_f32 v239, 0, v239
    v_pk_mul_f32 v[136:137], v[232:233], v[14:15] op_sel_hi:[1,0]
    v_pk_mul_f32 v[138:139], v[234:235], v[14:15] op_sel_hi:[1,0]
    v_pk_mul_f32 v[140:141], v[236:237], v[14:15] op_sel_hi:[1,0]
    v_pk_mul_f32 v[142:143], v[238:239], v[14:15] op_sel_hi:[1,0]
    v_pk_mul_f32 v[232:233], v[136:137], v[232:233]
    v_pk_mul_f32 v[234:235], v[138:139], v[234:235]
    v_pk_mul_f32 v[236:237], v[140:141], v[236:237]
    v_pk_mul_f32 v[238:239], v[142:143], v[238:239]
    v_cvt_pk_bf16_f32 v232, v232, v233
    v_cvt_pk_bf16_f32 v233, v234, v235
    v_cvt_pk_bf16_f32 v234, v236, v237
    v_cvt_pk_bf16_f32 v235, v238, v239
    buffer_store_dwordx4 v[232:235], v15, s[16:19], s43 offen offset:2560 sc1
    v_max_f32 v240, 0, v240
    v_max_f32 v241, 0, v241
    v_max_f32 v242, 0, v242
    v_max_f32 v243, 0, v243
    v_max_f32 v244, 0, v244
    v_max_f32 v245, 0, v245
    v_max_f32 v246, 0, v246
    v_max_f32 v247, 0, v247
    v_pk_mul_f32 v[136:137], v[240:241], v[14:15] op_sel_hi:[1,0]
    v_pk_mul_f32 v[138:139], v[242:243], v[14:15] op_sel_hi:[1,0]
    v_pk_mul_f32 v[140:141], v[244:245], v[14:15] op_sel_hi:[1,0]
    v_pk_mul_f32 v[142:143], v[246:247], v[14:15] op_sel_hi:[1,0]
    v_pk_mul_f32 v[240:241], v[136:137], v[240:241]
    v_pk_mul_f32 v[242:243], v[138:139], v[242:243]
    v_pk_mul_f32 v[244:245], v[140:141], v[244:245]
    v_pk_mul_f32 v[246:247], v[142:143], v[246:247]
    v_cvt_pk_bf16_f32 v240, v240, v241
    v_cvt_pk_bf16_f32 v241, v242, v243
    v_cvt_pk_bf16_f32 v242, v244, v245
    v_cvt_pk_bf16_f32 v243, v246, v247
    buffer_store_dwordx4 v[240:243], v15, s[16:19], s43 offen offset:3072 sc1
    v_max_f32 v248, 0, v248
    v_max_f32 v249, 0, v249
    v_max_f32 v250, 0, v250
    v_max_f32 v251, 0, v251
    v_max_f32 v252, 0, v252
    v_max_f32 v253, 0, v253
    v_max_f32 v254, 0, v254
    v_max_f32 v255, 0, v255
    v_pk_mul_f32 v[136:137], v[248:249], v[14:15] op_sel_hi:[1,0]
    v_pk_mul_f32 v[138:139], v[250:251], v[14:15] op_sel_hi:[1,0]
    v_pk_mul_f32 v[140:141], v[252:253], v[14:15] op_sel_hi:[1,0]
    v_pk_mul_f32 v[142:143], v[254:255], v[14:15] op_sel_hi:[1,0]
    v_pk_mul_f32 v[248:249], v[136:137], v[248:249]
    v_pk_mul_f32 v[250:251], v[138:139], v[250:251]
    v_pk_mul_f32 v[252:253], v[140:141], v[252:253]
    v_pk_mul_f32 v[254:255], v[142:143], v[254:255]
    v_cvt_pk_bf16_f32 v248, v248, v249
    v_cvt_pk_bf16_f32 v249, v250, v251
    v_cvt_pk_bf16_f32 v250, v252, v253
    v_cvt_pk_bf16_f32 v251, v254, v255
    buffer_store_dwordx4 v[248:251], v15, s[16:19], s43 offen offset:3584 sc1
    v_cvt_pk_bf16_f32 v112, v144, v145
    v_cvt_pk_bf16_f32 v113, v146, v147
    v_cvt_pk_bf16_f32 v114, v148, v149
    v_cvt_pk_bf16_f32 v115, v150, v151
    v_cvt_pk_bf16_f32 v116, v152, v153
    v_cvt_pk_bf16_f32 v117, v154, v155
    v_cvt_pk_bf16_f32 v118, v156, v157
    v_cvt_pk_bf16_f32 v119, v158, v159
    v_cvt_pk_bf16_f32 v120, v160, v161
    v_cvt_pk_bf16_f32 v121, v162, v163
    v_cvt_pk_bf16_f32 v122, v164, v165
    v_cvt_pk_bf16_f32 v123, v166, v167
    v_cvt_pk_bf16_f32 v124, v168, v169
    v_cvt_pk_bf16_f32 v125, v170, v171
    v_cvt_pk_bf16_f32 v126, v172, v173
    v_cvt_pk_bf16_f32 v127, v174, v175
    v_cvt_pk_bf16_f32 v128, v176, v177
    v_cvt_pk_bf16_f32 v129, v178, v179
    v_cvt_pk_bf16_f32 v130, v180, v181
    v_cvt_pk_bf16_f32 v131, v182, v183
    s_nop 1
    s_waitcnt vmcnt(0)
    v_mov_b32 v1, 1
    v_mov_b32 v2, 162560
    s_mov_b64 exec, 1
    ds_add_rtn_u32 v3, v2, v1
    s_waitcnt lgkmcnt(0)
    s_mov_b64 exec, -1
    v_readfirstlane_b32 s47, v3
    s_cmp_eq_u32 s47, 3
    s_cbranch_scc0 F_c1_nohf
    v_mov_b32 v1, s53
    v_mov_b32 v2, 0
    s_mov_b64 exec, 1
    buffer_store_dword v1, v2, s[16:19], s50 offen sc1
    s_mov_b64 exec, -1
F_c1_nohf:
    v_mfma_f32_32x32x16_bf16 v[64:79], v[16:19], v[112:115], 0
    v_mfma_f32_32x32x16_bf16 v[80:95], v[20:23], v[112:115], 0
    v_mfma_f32_32x32x16_bf16 v[64:79], v[24:27], v[116:119], v[64:79]
    v_mfma_f32_32x32x16_bf16 v[80:95], v[28:31], v[116:119], v[80:95]
    v_mfma_f32_32x32x16_bf16 v[96:111], v[32:35], v[120:123], 0
    v_mfma_f32_32x32x16_bf16 v[64:79], v[36:39], v[120:123], v[64:79]
    v_mfma_f32_32x32x16_bf16 v[80:95], v[40:43], v[120:123], v[80:95]
    v_mfma_f32_32x32x16_bf16 v[96:111], v[44:47], v[124:127], v[96:111]
    v_mfma_f32_32x32x16_bf16 v[80:95], v[48:51], v[124:127], v[80:95]
    v_mfma_f32_32x32x16_bf16 v[96:111], v[52:55], v[128:131], v[96:111]
    v_mfma_f32_32x32x16_bf16 v[80:95], v[56:59], v[128:131], v[80:95]
    s_nop 7
    s_nop 3
    v_max3_f32 v132, v64, v65, v66
    v_min3_f32 v133, v64, v65, v66
    v_max3_f32 v134, v67, v68, v69
    v_min3_f32 v135, v67, v68, v69
    v_max3_f32 v132, v132, v70, v71
    v_min3_f32 v133, v133, v70, v71
    v_max3_f32 v134, v134, v72, v73
    v_min3_f32 v135, v135, v72, v73
    v_max3_f32 v132, v132, v74, v75
    v_min3_f32 v133, v133, v74, v75
    v_max3_f32 v134, v134, v76, v77
    v_min3_f32 v135, v135, v76, v77
    v_max3_f32 v132, v132, v78, v79
    v_min3_f32 v133, v133, v78, v79
    v_max3_f32 v134, v134, v80, v81
    v_min3_f32 v135, v135, v80, v81
    v_max3_f32 v132, v132, v82, v83
    v_min3_f32 v133, v133, v82, v83
    v_max_f32 v132, v132, v134
    v_min_f32 v133, v133, v135
    v_mul_f32 v134, v12, v132
    v_mul_f32 v136, v12, v133
    v_pk_fma_f32 v[144:145], v[64:65], v[12:13], v[136:137] op_sel_hi:[1,0,0] neg_lo:[1,0,0] neg_hi:[1,0,0]
    v_pk_fma_f32 v[64:65], v[64:65], v[12:13], v[134:135] op_sel_hi:[1,0,0] neg_lo:[0,0,1] neg_hi:[0,0,1]
    v_pk_fma_f32 v[146:147], v[66:67], v[12:13], v[136:137] op_sel_hi:[1,0,0] neg_lo:[1,0,0] neg_hi:[1,0,0]
    v_pk_fma_f32 v[66:67], v[66:67], v[12:13], v[134:135] op_sel_hi:[1,0,0] neg_lo:[0,0,1] neg_hi:[0,0,1]
    v_pk_fma_f32 v[148:149], v[68:69], v[12:13], v[136:137] op_sel_hi:[1,0,0] neg_lo:[1,0,0] neg_hi:[1,0,0]
    v_pk_fma_f32 v[68:69], v[68:69], v[12:13], v[134:135] op_sel_hi:[1,0,0] neg_lo:[0,0,1] neg_hi:[0,0,1]
    v_pk_fma_f32 v[150:151], v[70:71], v[12:13], v[136:137] op_sel_hi:[1,0,0] neg_lo:[1,0,0] neg_hi:[1,0,0]
    v_pk_fma_f32 v[70:71], v[70:71], v[12:13], v[134:135] op_sel_hi:[1,0,0] neg_lo:[0,0,1] neg_hi:[0,0,1]
    v_pk_fma_f32 v[152:153], v[72:73], v[12:13], v[136:137] op_sel_hi:[1,0,0] neg_lo:[1,0,0] neg_hi:[1,0,0]
    v_pk_fma_f32 v[72:73], v[72:73], v[12:13], v[134:135] op_sel_hi:[1,0,0] neg_lo:[0,0,1] neg_hi:[0,0,1]
    v_pk_fma_f32 v[154:155], v[74:75], v[12:13], v[136:137] op_sel_hi:[1,0,0] neg_lo:[1,0,0] neg_hi:[1,0,0]
    v_pk_fma_f32 v[74:75], v[74:75], v[12:13], v[134:135] op_sel_hi:[1,0,0] neg_lo:[0,0,1] neg_hi:[0,0,1]
    v_pk_fma_f32 v[156:157], v[76:77], v[12:13], v[136:137] op_sel_hi:[1,0,0] neg_lo:[1,0,0] neg_hi:[1,0,0]
    v_pk_fma_f32 v[76:77], v[76:77], v[12:13], v[134:135] op_sel_hi:[1,0,0] neg_lo:[0,0,1] neg_hi:[0,0,1]
    v_pk_fma_f32 v[158:159], v[78:79], v[12:13], v[136:137] op_sel_hi:[1,0,0] neg_lo:[1,0,0] neg_hi:[1,0,0]
    v_pk_fma_f32 v[78:79], v[78:79], v[12:13], v[134:135] op_sel_hi:[1,0,0] neg_lo:[0,0,1] neg_hi:[0,0,1]
    v_pk_fma_f32 v[160:161], v[80:81], v[12:13], v[136:137] op_sel_hi:[1,0,0] neg_lo:[1,0,0] neg_hi:[1,0,0]
    v_pk_fma_f32 v[80:81], v[80:81], v[12:13], v[134:135] op_sel_hi:[1,0,0] neg_lo:[0,0,1] neg_hi:[0,0,1]
    v_pk_fma_f32 v[162:163], v[82:83], v[12:13], v[136:137] op_sel_hi:[1,0,0] neg_lo:[1,0,0] neg_hi:[1,0,0]
    v_pk_fma_f32 v[82:83], v[82:83], v[12:13], v[134:135] op_sel_hi:[1,0,0] neg_lo:[0,0,1] neg_hi:[0,0,1]
    v_exp_f32 v64, v64
    v_exp_f32 v144, v144
    v_exp_f32 v65, v65
    v_exp_f32 v145, v145
    v_exp_f32 v66, v66
    v_exp_f32 v146, v146
    v_exp_f32 v67, v67
    v_exp_f32 v147, v147
    v_exp_f32 v68, v68
    v_exp_f32 v148, v148
    v_exp_f32 v69, v69
    v_exp_f32 v149, v149
    v_exp_f32 v70, v70
    v_exp_f32 v150, v150
    v_exp_f32 v71, v71
    v_exp_f32 v151, v151
    v_exp_f32 v72, v72
    v_exp_f32 v152, v152
    v_exp_f32 v73, v73
    v_exp_f32 v153, v153
    v_exp_f32 v74, v74
    v_exp_f32 v154, v154
    v_exp_f32 v75, v75
    v_exp_f32 v155, v155
    v_exp_f32 v76, v76
    v_exp_f32 v156, v156
    v_exp_f32 v77, v77
    v_exp_f32 v157, v157
    v_exp_f32 v78, v78
    v_exp_f32 v158, v158
    v_exp_f32 v79, v79
    v_exp_f32 v159, v159
    v_exp_f32 v80, v80
    v_exp_f32 v160, v160
    v_exp_f32 v81, v81
    v_exp_f32 v161, v161
    v_exp_f32 v82, v82
    v_exp_f32 v162, v162
    v_exp_f32 v83, v83
    v_exp_f32 v163, v163
    v_pk_add_f32 v[138:139], v[64:65], v[66:67]
    v_pk_add_f32 v[140:141], v[144:145], v[146:147]
    v_pk_add_f32 v[138:139], v[138:139], v[68:69]
    v_pk_add_f32 v[140:141], v[140:141], v[148:149]
    v_pk_add_f32 v[138:139], v[138:139], v[70:71]
    v_pk_add_f32 v[140:141], v[140:141], v[150:151]
    v_pk_add_f32 v[138:139], v[138:139], v[72:73]
    v_pk_add_f32 v[140:141], v[140:141], v[152:153]
    v_pk_add_f32 v[138:139], v[138:139], v[74:75]
    v_pk_add_f32 v[140:141], v[140:141], v[154:155]
    v_pk_add_f32 v[138:139], v[138:139], v[76:77]
    v_pk_add_f32 v[140:141], v[140:141], v[156:157]
    v_pk_add_f32 v[138:139], v[138:139], v[78:79]
    v_pk_add_f32 v[140:141], v[140:141], v[158:159]
    v_pk_add_f32 v[138:139], v[138:139], v[80:81]
    v_pk_add_f32 v[140:141], v[140:141], v[160:161]
    v_pk_add_f32 v[138:139], v[138:139], v[82:83]
    v_pk_add_f32 v[140:141], v[140:141], v[162:163]
    v_add_f32 v138, v138, v139
    v_add_f32 v140, v140, v141
    v_rcp_f32 v138, v138
    v_rcp_f32 v140, v140
    s_nop 0
    v_pk_mul_f32 v[64:65], v[64:65], v[138:139] op_sel_hi:[1,0]
    v_pk_mul_f32 v[144:145], v[144:145], v[140:141] op_sel_hi:[1,0]
    v_pk_mul_f32 v[66:67], v[66:67], v[138:139] op_sel_hi:[1,0]
    v_pk_mul_f32 v[146:147], v[146:147], v[140:141] op_sel_hi:[1,0]
    v_pk_mul_f32 v[68:69], v[68:69], v[138:139] op_sel_hi:[1,0]
    v_pk_mul_f32 v[148:149], v[148:149], v[140:141] op_sel_hi:[1,0]
    v_pk_mul_f32 v[70:71], v[70:71], v[138:139] op_sel_hi:[1,0]
    v_pk_mul_f32 v[150:151], v[150:151], v[140:141] op_sel_hi:[1,0]
    v_pk_mul_f32 v[72:73], v[72:73], v[138:139] op_sel_hi:[1,0]
    v_pk_mul_f32 v[152:153], v[152:153], v[140:141] op_sel_hi:[1,0]
    v_pk_mul_f32 v[74:75], v[74:75], v[138:139] op_sel_hi:[1,0]
    v_pk_mul_f32 v[154:155], v[154:155], v[140:141] op_sel_hi:[1,0]
    v_pk_mul_f32 v[76:77], v[76:77], v[138:139] op_sel_hi:[1,0]
    v_pk_mul_f32 v[156:157], v[156:157], v[140:141] op_sel_hi:[1,0]
    v_pk_mul_f32 v[78:79], v[78:79], v[138:139] op_sel_hi:[1,0]
    v_pk_mul_f32 v[158:159], v[158:159], v[140:141] op_sel_hi:[1,0]
    v_pk_mul_f32 v[80:81], v[80:81], v[138:139] op_sel_hi:[1,0]
    v_pk_mul_f32 v[160:161], v[160:161], v[140:141] op_sel_hi:[1,0]
    v_pk_mul_f32 v[82:83], v[82:83], v[138:139] op_sel_hi:[1,0]
    v_pk_mul_f32 v[162:163], v[162:163], v[140:141] op_sel_hi:[1,0]
    v_cvt_pk_bf16_f32 v16, v64, v65
    v_cvt_pk_bf16_f32 v24, v144, v145
    v_cvt_pk_bf16_f32 v17, v66, v67
    v_cvt_pk_bf16_f32 v25, v146, v147
    v_cvt_pk_bf16_f32 v18, v68, v69
    v_cvt_pk_bf16_f32 v26, v148, v149
    v_cvt_pk_bf16_f32 v19, v70, v71
    v_cvt_pk_bf16_f32 v27, v150, v151
    v_cvt_pk_bf16_f32 v20, v72, v73
    v_cvt_pk_bf16_f32 v28, v152, v153
    v_cvt_pk_bf16_f32 v21, v74, v75
    v_cvt_pk_bf16_f32 v29, v154, v155
    v_cvt_pk_bf16_f32 v22, v76, v77
    v_cvt_pk_bf16_f32 v30, v156, v157
    v_cvt_pk_bf16_f32 v23, v78, v79
    v_cvt_pk_bf16_f32 v31, v158, v159
    v_cvt_pk_bf16_f32 v32, v80, v81
    v_cvt_pk_bf16_f32 v34, v160, v161
    v_cvt_pk_bf16_f32 v33, v82, v83
    v_cvt_pk_bf16_f32 v35, v162, v163
    v_max3_f32 v132, v84, v85, v86
    v_min3_f32 v133, v84, v85, v86
    v_max3_f32 v134, v87, v88, v89
    v_min3_f32 v135, v87, v88, v89
    v_max3_f32 v132, v132, v90, v91
    v_min3_f32 v133, v133, v90, v91
    v_max3_f32 v134, v134, v92, v93
    v_min3_f32 v135, v135, v92, v93
    v_max3_f32 v132, v132, v94, v95
    v_min3_f32 v133, v133, v94, v95
    v_max3_f32 v134, v134, v96, v97
    v_min3_f32 v135, v135, v96, v97
    v_max3_f32 v132, v132, v98, v99
    v_min3_f32 v133, v133, v98, v99
    v_max3_f32 v134, v134, v100, v101
    v_min3_f32 v135, v135, v100, v101
    v_max3_f32 v132, v132, v102, v103
    v_min3_f32 v133, v133, v102, v103
    v_max_f32 v132, v132, v134
    v_min_f32 v133, v133, v135
    v_mul_f32 v134, v12, v132
    v_mul_f32 v136, v12, v133
    v_pk_fma_f32 v[164:165], v[84:85], v[12:13], v[136:137] op_sel_hi:[1,0,0] neg_lo:[1,0,0] neg_hi:[1,0,0]
    v_pk_fma_f32 v[84:85], v[84:85], v[12:13], v[134:135] op_sel_hi:[1,0,0] neg_lo:[0,0,1] neg_hi:[0,0,1]
    v_pk_fma_f32 v[166:167], v[86:87], v[12:13], v[136:137] op_sel_hi:[1,0,0] neg_lo:[1,0,0] neg_hi:[1,0,0]
    v_pk_fma_f32 v[86:87], v[86:87], v[12:13], v[134:135] op_sel_hi:[1,0,0] neg_lo:[0,0,1] neg_hi:[0,0,1]
    v_pk_fma_f32 v[168:169], v[88:89], v[12:13], v[136:137] op_sel_hi:[1,0,0] neg_lo:[1,0,0] neg_hi:[1,0,0]
    v_pk_fma_f32 v[88:89], v[88:89], v[12:13], v[134:135] op_sel_hi:[1,0,0] neg_lo:[0,0,1] neg_hi:[0,0,1]
    v_pk_fma_f32 v[170:171], v[90:91], v[12:13], v[136:137] op_sel_hi:[1,0,0] neg_lo:[1,0,0] neg_hi:[1,0,0]
    v_pk_fma_f32 v[90:91], v[90:91], v[12:13], v[134:135] op_sel_hi:[1,0,0] neg_lo:[0,0,1] neg_hi:[0,0,1]
    v_pk_fma_f32 v[172:173], v[92:93], v[12:13], v[136:137] op_sel_hi:[1,0,0] neg_lo:[1,0,0] neg_hi:[1,0,0]
    v_pk_fma_f32 v[92:93], v[92:93], v[12:13], v[134:135] op_sel_hi:[1,0,0] neg_lo:[0,0,1] neg_hi:[0,0,1]
    v_pk_fma_f32 v[174:175], v[94:95], v[12:13], v[136:137] op_sel_hi:[1,0,0] neg_lo:[1,0,0] neg_hi:[1,0,0]
    v_pk_fma_f32 v[94:95], v[94:95], v[12:13], v[134:135] op_sel_hi:[1,0,0] neg_lo:[0,0,1] neg_hi:[0,0,1]
    v_pk_fma_f32 v[176:177], v[96:97], v[12:13], v[136:137] op_sel_hi:[1,0,0] neg_lo:[1,0,0] neg_hi:[1,0,0]
    v_pk_fma_f32 v[96:97], v[96:97], v[12:13], v[134:135] op_sel_hi:[1,0,0] neg_lo:[0,0,1] neg_hi:[0,0,1]
    v_pk_fma_f32 v[178:179], v[98:99], v[12:13], v[136:137] op_sel_hi:[1,0,0] neg_lo:[1,0,0] neg_hi:[1,0,0]
    v_pk_fma_f32 v[98:99], v[98:99], v[12:13], v[134:135] op_sel_hi:[1,0,0] neg_lo:[0,0,1] neg_hi:[0,0,1]
    v_pk_fma_f32 v[180:181], v[100:101], v[12:13], v[136:137] op_sel_hi:[1,0,0] neg_lo:[1,0,0] neg_hi:[1,0,0]
    v_pk_fma_f32 v[100:101], v[100:101], v[12:13], v[134:135] op_sel_hi:[1,0,0] neg_lo:[0,0,1] neg_hi:[0,0,1]
    v_pk_fma_f32 v[182:183], v[102:103], v[12:13], v[136:137] op_sel_hi:[1,0,0] neg_lo:[1,0,0] neg_hi:[1,0,0]
    v_pk_fma_f32 v[102:103], v[102:103], v[12:13], v[134:135] op_sel_hi:[1,0,0] neg_lo:[0,0,1] neg_hi:[0,0,1]
    v_exp_f32 v84, v84
    v_exp_f32 v164, v164
    v_exp_f32 v85, v85
    v_exp_f32 v165, v165
    v_exp_f32 v86, v86
    v_exp_f32 v166, v166
    v_exp_f32 v87, v87
    v_exp_f32 v167, v167
    v_exp_f32 v88, v88
    v_exp_f32 v168, v168
    v_exp_f32 v89, v89
    v_exp_f32 v169, v169
    v_exp_f32 v90, v90
    v_exp_f32 v170, v170
    v_exp_f32 v91, v91
    v_exp_f32 v171, v171
    v_exp_f32 v92, v92
    v_exp_f32 v172, v172
    v_exp_f32 v93, v93
    v_exp_f32 v173, v173
    v_exp_f32 v94, v94
    v_exp_f32 v174, v174
    v_exp_f32 v95, v95
    v_exp_f32 v175, v175
    v_exp_f32 v96, v96
    v_exp_f32 v176, v176
    v_exp_f32 v97, v97
    v_exp_f32 v177, v177
    v_exp_f32 v98, v98
    v_exp_f32 v178, v178
    v_exp_f32 v99, v99
    v_exp_f32 v179, v179
    v_exp_f32 v100, v100
    v_exp_f32 v180, v180
    v_exp_f32 v101, v101
    v_exp_f32 v181, v181
    v_exp_f32 v102, v102
    v_exp_f32 v182, v182
    v_exp_f32 v103, v103
    v_exp_f32 v183, v183
    v_pk_add_f32 v[138:139], v[84:85], v[86:87]
    v_pk_add_f32 v[140:141], v[164:165], v[166:167]
    v_pk_add_f32 v[138:139], v[138:139], v[88:89]
    v_pk_add_f32 v[140:141], v[140:141], v[168:169]
    v_pk_add_f32 v[138:139], v[138:139], v[90:91]
    v_pk_add_f32 v[140:141], v[140:141], v[170:171]
    v_pk_add_f32 v[138:139], v[138:139], v[92:93]
    v_pk_add_f32 v[140:141], v[140:141], v[172:173]
    v_pk_add_f32 v[138:139], v[138:139], v[94:95]
    v_pk_add_f32 v[140:141], v[140:141], v[174:175]
    v_pk_add_f32 v[138:139], v[138:139], v[96:97]
    v_pk_add_f32 v[140:141], v[140:141], v[176:177]
    v_pk_add_f32 v[138:139], v[138:139], v[98:99]
    v_pk_add_f32 v[140:141], v[140:141], v[178:179]
    v_pk_add_f32 v[138:139], v[138:139], v[100:101]
    v_pk_add_f32 v[140:141], v[140:141], v[180:181]
    v_pk_add_f32 v[138:139], v[138:139], v[102:103]
    v_pk_add_f32 v[140:141], v[140:141], v[182:183]
    v_add_f32 v138, v138, v139
    v_add_f32 v140, v140, v141
    v_rcp_f32 v138, v138
    v_rcp_f32 v140, v140
    s_nop 0
    v_pk_mul_f32 v[84:85], v[84:85], v[138:139] op_sel_hi:[1,0]
    v_pk_mul_f32 v[164:165], v[164:165], v[140:141] op_sel_hi:[1,0]
    v_pk_mul_f32 v[86:87], v[86:87], v[138:139] op_sel_hi:[1,0]
    v_pk_mul_f32 v[166:167], v[166:167], v[140:141] op_sel_hi:[1,0]
    v_pk_mul_f32 v[88:89], v[88:89], v[138:139] op_sel_hi:[1,0]
    v_pk_mul_f32 v[168:169], v[168:169], v[140:141] op_sel_hi:[1,0]
    v_pk_mul_f32 v[90:91], v[90:91], v[138:139] op_sel_hi:[1,0]
    v_pk_mul_f32 v[170:171], v[170:171], v[140:141] op_sel_hi:[1,0]
    v_pk_mul_f32 v[92:93], v[92:93], v[138:139] op_sel_hi:[1,0]
    v_pk_mul_f32 v[172:173], v[172:173], v[140:141] op_sel_hi:[1,0]
    v_pk_mul_f32 v[94:95], v[94:95], v[138:139] op_sel_hi:[1,0]
    v_pk_mul_f32 v[174:175], v[174:175], v[140:141] op_sel_hi:[1,0]
    v_pk_mul_f32 v[96:97], v[96:97], v[138:139] op_sel_hi:[1,0]
    v_pk_mul_f32 v[176:177], v[176:177], v[140:141] op_sel_hi:[1,0]
    v_pk_mul_f32 v[98:99], v[98:99], v[138:139] op_sel_hi:[1,0]
    v_pk_mul_f32 v[178:179], v[178:179], v[140:141] op_sel_hi:[1,0]
    v_pk_mul_f32 v[100:101], v[100:101], v[138:139] op_sel_hi:[1,0]
    v_pk_mul_f32 v[180:181], v[180:181], v[140:141] op_sel_hi:[1,0]
    v_pk_mul_f32 v[102:103], v[102:103], v[138:139] op_sel_hi:[1,0]
    v_pk_mul_f32 v[182:183], v[182:183], v[140:141] op_sel_hi:[1,0]
    v_cvt_pk_bf16_f32 v36, v84, v85
    v_cvt_pk_bf16_f32 v44, v164, v165
    v_cvt_pk_bf16_f32 v37, v86, v87
    v_cvt_pk_bf16_f32 v45, v166, v167
    v_cvt_pk_bf16_f32 v38, v88, v89
    v_cvt_pk_bf16_f32 v46, v168, v169
    v_cvt_pk_bf16_f32 v39, v90, v91
    v_cvt_pk_bf16_f32 v47, v170, v171
    v_cvt_pk_bf16_f32 v40, v92, v93
    v_cvt_pk_bf16_f32 v48, v172, v173
    v_cvt_pk_bf16_f32 v41, v94, v95
    v_cvt_pk_bf16_f32 v49, v174, v175
    v_cvt_pk_bf16_f32 v42, v96, v97
    v_cvt_pk_bf16_f32 v50, v176, v177
    v_cvt_pk_bf16_f32 v43, v98, v99
    v_cvt_pk_bf16_f32 v51, v178, v179
    v_cvt_pk_bf16_f32 v52, v100, v101
    v_cvt_pk_bf16_f32 v54, v180, v181
    v_cvt_pk_bf16_f32 v53, v102, v103
    v_cvt_pk_bf16_f32 v55, v182, v183
    v_permlane32_swap_b32 v16, v20
    v_permlane32_swap_b32 v17, v21
    v_permlane32_swap_b32 v18, v22
    v_permlane32_swap_b32 v19, v23
    v_permlane32_swap_b32 v24, v28
    v_permlane32_swap_b32 v25, v29
    v_permlane32_swap_b32 v26, v30
    v_permlane32_swap_b32 v27, v31
    v_permlane32_swap_b32 v36, v40
    v_permlane32_swap_b32 v37, v41
    v_permlane32_swap_b32 v38, v42
    v_permlane32_swap_b32 v39, v43
    v_permlane32_swap_b32 v44, v48
    v_permlane32_swap_b32 v45, v49
    v_permlane32_swap_b32 v46, v50
    v_permlane32_swap_b32 v47, v51
    v_lshrrev_b32 v3, 4, v60
    v_mul_u32_u24 v4, 1792, v3
    v_and_b32 v5, 15, v60
    v_lshl_add_u32 v4, v5, 4, v4
    v_lshlrev_b32 v12, 7, v5
    s_lshl_b32 s45, s29, 11
    s_add_u32 s45, s45, 2129920
    s_lshl_b32 s33, s29, 2
    s_add_u32 s33, s33, s31
    s_mul_i32 s33, s33, 28672
    s_add_u32 s33, s33, 262144
    v_and_b32 v6, 1, v60
    v_lshlrev_b32 v6, 4, v6
    v_mov_b32 v7, 0x3f80
    v_lshlrev_b32 v6, v6, v7
    v_lshrrev_b32 v7, 1, v5
    v_cmp_eq_u32 vcc, 0, v7
    s_nop 1
    v_cndmask_b32 v56, 0, v6, vcc
    v_cmp_eq_u32 vcc, 1, v7
    s_nop 1
    v_cndmask_b32 v57, 0, v6, vcc
    v_cmp_eq_u32 vcc, 2, v7
    s_nop 1
    v_cndmask_b32 v58, 0, v6, vcc
    v_cmp_eq_u32 vcc, 3, v7
    s_nop 1
    v_cndmask_b32 v59, 0, v6, vcc
    s_mul_i32 s34, s31, 1792
    s_add_u32 s34, s34, 147200
    v_lshlrev_b32 v5, 4, v5
    v_bfe_u32 v6, v60, 4, 1
    v_lshl_add_u32 v5, v6, 3, v5
    v_add_u32 v5, s34, v5
    v_and_b32 v6, 31, v60
    v_min_u32 v6, 20, v6
    v_lshrrev_b32 v7, 5, v60
    v_mul_u32_u24 v8, 336, v7
    v_lshlrev_b32 v6, 4, v6
    v_add_u32 v6, 147200, v6
    v_add_u32 v8, v8, v6
    v_add_u32 v6, 1344, v6
    v_mov_b32 v9, 143872
    v_cmp_gt_u32 vcc, 32, v60
    v_add_u32 v10, 3584, v6
    s_mov_b32 s38, 0x01ff01ff
    s_mov_b32 s39, 0x01ff01ff
    v_cndmask_b32 v6, v9, v6, vcc
    v_cndmask_b32 v10, v10, v9, vcc
    s_cmp_eq_u32 s31, 0
    s_cbranch_scc0 F_o1w
    s_mov_b32 s48, 0
    s_mov_b64 exec, 0xffff
F_o1:
    buffer_load_dword v3, v12, s[16:19], s45 offen sc1
    s_add_u32 s48, s48, 1
    s_waitcnt vmcnt(0)
    v_cmp_eq_u32 vcc, s53, v3
    s_mov_b32 s47, 3
    s_cmp_ge_u32 s48, 262144
    s_cbranch_scc1 F_o1x
    s_and_b32 s36, vcc_lo, 0xff
    s_cmp_eq_u32 s36, 0xff
    s_cselect_b32 s47, 1, 0
    s_cmp_ge_u32 vcc_lo, 0xff00
    s_cselect_b32 s36, 2, 0
    s_or_b32 s47, s47, s36
    s_cbranch_scc0 F_o1
F_o1x:
    v_mov_b32 v1, s47
    v_mov_b32 v2, 162572
    ds_write_b32 v2, v1
    s_mov_b64 exec, -1
    s_branch F_o1y
F_o1w:
    v_mov_b32 v2, 162572
    s_mov_b32 s48, 0
spin_14:
    ds_read_b32 v3, v2
    s_add_u32 s48, s48, 1
    s_waitcnt lgkmcnt(0)
    v_readfirstlane_b32 s47, v3
    s_cmp_ge_u32 s48, 262144
    s_cbranch_scc1 spin_14_x
    s_cmp_lt_u32 s47, 1
    s_cbranch_scc1 spin_14
spin_14_x:
F_o1y:
    s_mov_b32 s34, s47
    s_cmp_eq_u32 s47, 2
    s_cselect_b32 s35, 14336, 0
    s_add_u32 s36, s33, s35
    s_xor_b32 s35, s35, 14336
    s_add_u32 s35, s33, s35
    s_add_u32 s37, s36, 7168
    s_add_u32 s44, s35, 7168
    s_mov_b32 s49, 0
F_o2:
    buffer_load_dwordx4 v[140:143], v4, s[16:19], s36 offen offset:0 sc1
    buffer_load_dwordx4 v[144:147], v4, s[16:19], s36 offen offset:256 sc1
    buffer_load_dwordx4 v[148:151], v4, s[16:19], s36 offen offset:512 sc1
    buffer_load_dwordx4 v[152:155], v4, s[16:19], s36 offen offset:768 sc1
    buffer_load_dwordx4 v[156:159], v4, s[16:19], s36 offen offset:1024 sc1
    buffer_load_dwordx4 v[160:163], v4, s[16:19], s36 offen offset:1280 sc1
    buffer_load_dwordx4 v[164:167], v4, s[16:19], s36 offen offset:1536 sc1
    buffer_load_dwordx4 v[168:171], v4, s[16:19], s37 offen offset:0 sc1
    buffer_load_dwordx4 v[172:175], v4, s[16:19], s37 offen offset:256 sc1
    buffer_load_dwordx4 v[176:179], v4, s[16:19], s37 offen offset:512 sc1
    buffer_load_dwordx4 v[180:183], v4, s[16:19], s37 offen offset:768 sc1
    buffer_load_dwordx4 v[184:187], v4, s[16:19], s37 offen offset:1024 sc1
    buffer_load_dwordx4 v[188:191], v4, s[16:19], s37 offen offset:1280 sc1
    buffer_load_dwordx4 v[192:195], v4, s[16:19], s37 offen offset:1536 sc1
    s_cmp_eq_u32 s34, 3
    s_cbranch_scc1 F_o3x
    s_cmp_eq_u32 s31, 0
    s_cbranch_scc0 F_o3w
    s_mov_b64 s[40:41], 0xffff
    v_lshlrev_b32 v1, 7, v60
    s_mov_b32 s48, 0
    s_mov_b64 exec, s[40:41]
poll_15:
    buffer_load_dword v2, v1, s[16:19], s45 offen sc1
    s_add_u32 s48, s48, 1
    s_waitcnt vmcnt(0)
    v_cmp_eq_u32 vcc, s53, v2
    s_cmp_ge_u32 s48, 262144
    s_cbranch_scc1 poll_15_x
    s_cmp_eq_u64 vcc, s[40:41]
    s_cbranch_scc0 poll_15
poll_15_x:
    s_mov_b64 exec, -1
    v_mov_b32 v1, 1
    v_mov_b32 v2, 162568
    ds_write_b32 v2, v1
    s_branch F_o3x
F_o3w:
    v_mov_b32 v2, 162568
    s_mov_b32 s48, 0
spin_16:
    ds_read_b32 v3, v2
    s_add_u32 s48, s48, 1
    s_waitcnt lgkmcnt(0)
    v_readfirstlane_b32 s47, v3
    s_cmp_ge_u32 s48, 262144
    s_cbranch_scc1 spin_16_x
    s_cmp_lt_u32 s47, 1
    s_cbranch_scc1 spin_16
spin_16_x:
F_o3x:
    s_mov_b32 s34, 3
    buffer_load_dwordx4 v[196:199], v4, s[16:19], s35 offen offset:0 sc1
    buffer_load_dwordx4 v[200:203], v4, s[16:19], s35 offen offset:256 sc1
    buffer_load_dwordx4 v[204:207], v4, s[16:19], s35 offen offset:512 sc1
    buffer_load_dwordx4 v[208:211], v4, s[16:19], s35 offen offset:768 sc1
    buffer_load_dwordx4 v[212:215], v4, s[16:19], s35 offen offset:1024 sc1
    buffer_load_dwordx4 v[216:219], v4, s[16:19], s35 offen offset:1280 sc1
    buffer_load_dwordx4 v[220:223], v4, s[16:19], s35 offen offset:1536 sc1
    buffer_load_dwordx4 v[224:227], v4, s[16:19], s44 offen offset:0 sc1
    buffer_load_dwordx4 v[228:231], v4, s[16:19], s44 offen offset:256 sc1
    buffer_load_dwordx4 v[232:235], v4, s[16:19], s44 offen offset:512 sc1
    buffer_load_dwordx4 v[236:239], v4, s[16:19], s44 offen offset:768 sc1
    buffer_load_dwordx4 v[240:243], v4, s[16:19], s44 offen offset:1024 sc1
    buffer_load_dwordx4 v[244:247], v4, s[16:19], s44 offen offset:1280 sc1
    buffer_load_dwordx4 v[248:251], v4, s[16:19], s44 offen offset:1536 sc1
    s_waitcnt vmcnt(14)
F_ov0:
    v_max3_u32 v11, v143, v147, v151
    v_max3_u32 v13, v155, v159, v163
    v_max3_u32 v11, v11, v171, v175
    v_max3_u32 v13, v13, v179, v183
    v_max3_u32 v11, v11, v187, v191
    v_max_u32 v14, v167, v195
    v_max_u32 v11, v11, v13
    v_cmp_eq_u32 s[46:47], -1, v14
    v_cmp_eq_u32 vcc, -1, v11
    s_add_u32 s49, s49, 1
    s_and_b64 s[46:47], s[46:47], s[38:39]
    s_or_b64 vcc, vcc, s[46:47]
    s_cmp_ge_u32 s49, 262144
    s_cselect_b64 vcc, 0, vcc
    s_cbranch_vccnz F_or0
    v_mfma_f32_16x16x32_bf16 v[64:67], v[56:59], v[140:143], 0
    v_mfma_f32_16x16x32_bf16 v[68:71], v[56:59], v[144:147], 0
    v_mfma_f32_16x16x32_bf16 v[72:75], v[56:59], v[148:151], 0
    v_mfma_f32_16x16x32_bf16 v[76:79], v[56:59], v[152:155], 0
    v_mfma_f32_16x16x32_bf16 v[80:83], v[56:59], v[156:159], 0
    v_mfma_f32_16x16x32_bf16 v[84:87], v[56:59], v[160:163], 0
    v_mfma_f32_16x16x32_bf16 v[88:91], v[56:59], v[164:167], 0
    v_mfma_f32_16x16x32_bf16 v[64:67], v[56:59], v[168:171], v[64:67]
    v_mfma_f32_16x16x32_bf16 v[68:71], v[56:59], v[172:175], v[68:71]
    v_mfma_f32_16x16x32_bf16 v[72:75], v[56:59], v[176:179], v[72:75]
    v_mfma_f32_16x16x32_bf16 v[76:79], v[56:59], v[180:183], v[76:79]
    v_mfma_f32_16x16x32_bf16 v[80:83], v[56:59], v[184:187], v[80:83]
    v_mfma_f32_16x16x32_bf16 v[84:87], v[56:59], v[188:191], v[84:87]
    v_mfma_f32_16x16x32_bf16 v[88:91], v[56:59], v[192:195], v[88:91]
    s_waitcnt vmcnt(0)
F_ov1:
    v_max3_u32 v11, v199, v203, v207
    v_max3_u32 v13, v211, v215, v219
    v_max3_u32 v11, v11, v227, v231
    v_max3_u32 v13, v13, v235, v239
    v_max3_u32 v11, v11, v243, v247
    v_max_u32 v14, v223, v251
    v_max_u32 v11, v11, v13
    v_cmp_eq_u32 s[46:47], -1, v14
    v_cmp_eq_u32 vcc, -1, v11
    s_add_u32 s49, s49, 1
    s_and_b64 s[46:47], s[46:47], s[38:39]
    s_or_b64 vcc, vcc, s[46:47]
    s_cmp_ge_u32 s49, 262144
    s_cselect_b64 vcc, 0, vcc
    s_cbranch_vccnz F_or1
    v_mfma_f32_16x16x32_bf16 v[64:67], v[56:59], v[196:199], v[64:67]
    v_mfma_f32_16x16x32_bf16 v[68:71], v[56:59], v[200:203], v[68:71]
    v_mfma_f32_16x16x32_bf16 v[72:75], v[56:59], v[204:207], v[72:75]
    v_mfma_f32_16x16x32_bf16 v[76:79], v[56:59], v[208:211], v[76:79]
    v_mfma_f32_16x16x32_bf16 v[80:83], v[56:59], v[212:215], v[80:83]
    v_mfma_f32_16x16x32_bf16 v[84:87], v[56:59], v[216:219], v[84:87]
    v_mfma_f32_16x16x32_bf16 v[88:91], v[56:59], v[220:223], v[88:91]
    v_mfma_f32_16x16x32_bf16 v[64:67], v[56:59], v[224:227], v[64:67]
    v_mfma_f32_16x16x32_bf16 v[68:71], v[56:59], v[228:231], v[68:71]
    v_mfma_f32_16x16x32_bf16 v[72:75], v[56:59], v[232:235], v[72:75]
    v_mfma_f32_16x16x32_bf16 v[76:79], v[56:59], v[236:239], v[76:79]
    v_mfma_f32_16x16x32_bf16 v[80:83], v[56:59], v[240:243], v[80:83]
    v_mfma_f32_16x16x32_bf16 v[84:87], v[56:59], v[244:247], v[84:87]
    v_mfma_f32_16x16x32_bf16 v[88:91], v[56:59], v[248:251], v[88:91]
    s_nop 0
    s_mov_b32 exec_hi, 0
    v_cvt_pk_bf16_f32 v96, v64, v65
    v_cvt_pk_bf16_f32 v97, v66, v67
    ds_write_b64 v5, v[96:97] offset:0
    v_cvt_pk_bf16_f32 v98, v68, v69
    v_cvt_pk_bf16_f32 v99, v70, v71
    ds_write_b64 v5, v[98:99] offset:256
    v_cvt_pk_bf16_f32 v100, v72, v73
    v_cvt_pk_bf16_f32 v101, v74, v75
    ds_write_b64 v5, v[100:101] offset:512
    v_cvt_pk_bf16_f32 v102, v76, v77
    v_cvt_pk_bf16_f32 v103, v78, v79
    ds_write_b64 v5, v[102:103] offset:768
    v_cvt_pk_bf16_f32 v104, v80, v81
    v_cvt_pk_bf16_f32 v105, v82, v83
    ds_write_b64 v5, v[104:105] offset:1024
    v_cvt_pk_bf16_f32 v106, v84, v85
    v_cvt_pk_bf16_f32 v107, v86, v87
    ds_write_b64 v5, v[106:107] offset:1280
    v_cvt_pk_bf16_f32 v108, v88, v89
    v_cvt_pk_bf16_f32 v109, v90, v91
    ds_write_b64 v5, v[108:109] offset:1536
    v_mov_b32 v1, 1
    v_mov_b32 v2, 162576
    s_mov_b64 exec, 1
    ds_add_u32 v2, v1
    s_mov_b64 exec, -1
    v_mov_b32 v2, 162576
    s_mov_b32 s48, 0
spin_17:
    ds_read_b32 v3, v2
    s_add_u32 s48, s48, 1
    s_waitcnt lgkmcnt(0)
    v_readfirstlane_b32 s47, v3
    s_cmp_ge_u32 s48, 262144
    s_cbranch_scc1 spin_17_x
    s_cmp_lt_u32 s47, 4
    s_cbranch_scc1 spin_17
spin_17_x:
    ds_read_b128 v[64:67], v8 offset:0
    ds_read_b128 v[68:71], v8 offset:672
    ds_read_b128 v[72:75], v6 offset:0
    ds_read_b128 v[76:79], v8 offset:1792
    ds_read_b128 v[80:83], v8 offset:2464
    ds_read_b128 v[84:87], v6 offset:1792
    ds_read_b128 v[88:91], v8 offset:3584
    ds_read_b128 v[92:95], v8 offset:4256
    ds_read_b128 v[96:99], v10 offset:0
    ds_read_b128 v[100:103], v8 offset:5376
    ds_read_b128 v[104:107], v8 offset:6048
    ds_read_b128 v[108:111], v10 offset:1792
    s_waitcnt lgkmcnt(9)
    v_mfma_f32_32x32x16_bf16 v[128:143], v[64:67], v[16:19], 0
    s_waitcnt lgkmcnt(6)
    v_mfma_f32_32x32x16_bf16 v[144:159], v[76:79], v[36:39], 0
    v_mfma_f32_32x32x16_bf16 v[128:143], v[68:71], v[24:27], v[128:143]
    v_mfma_f32_32x32x16_bf16 v[144:159], v[80:83], v[44:47], v[144:159]
    v_mfma_f32_32x32x16_bf16 v[128:143], v[72:75], v[32:35], v[128:143]
    v_mfma_f32_32x32x16_bf16 v[144:159], v[84:87], v[52:55], v[144:159]
    s_waitcnt lgkmcnt(3)
    v_mfma_f32_32x32x16_bf16 v[160:175], v[88:91], v[20:23], 0
    s_waitcnt lgkmcnt(0)
    v_mfma_f32_32x32x16_bf16 v[176:191], v[100:103], v[40:43], 0
    s_nop 6
    v_add_f32 v140, 0x358637bd, v140
    v_rcp_f32 v140, v140
    s_nop 0
    v_pk_mul_f32 v[128:129], v[128:129], v[140:141] op_sel_hi:[1,0]
    v_pk_mul_f32 v[130:131], v[130:131], v[140:141] op_sel_hi:[1,0]
    v_pk_mul_f32 v[132:133], v[132:133], v[140:141] op_sel_hi:[1,0]
    v_mfma_f32_32x32x16_bf16 v[160:175], v[92:95], v[28:31], v[160:175]
    v_pk_mul_f32 v[134:135], v[134:135], v[140:141] op_sel_hi:[1,0]
    v_pk_mul_f32 v[136:137], v[136:137], v[140:141] op_sel_hi:[1,0]
    v_pk_mul_f32 v[138:139], v[138:139], v[140:141] op_sel_hi:[1,0]
    v_cvt_pk_bf16_f32 v128, v128, v129
    v_cvt_pk_bf16_f32 v129, v130, v131
    v_cvt_pk_bf16_f32 v130, v132, v133
    v_cvt_pk_bf16_f32 v131, v134, v135
    v_mfma_f32_32x32x16_bf16 v[176:191], v[104:107], v[48:51], v[176:191]
    v_cvt_pk_bf16_f32 v112, v136, v137
    v_cvt_pk_bf16_f32 v113, v138, v139
    buffer_store_dwordx4 v[128:131], v15, s[16:19], s56 offen offset:0 sc1
    v_add_f32 v156, 0x358637bd, v156
    v_rcp_f32 v156, v156
    s_nop 0
    v_pk_mul_f32 v[144:145], v[144:145], v[156:157] op_sel_hi:[1,0]
    v_mfma_f32_32x32x16_bf16 v[160:175], v[96:99], v[32:35], v[160:175]
    v_pk_mul_f32 v[146:147], v[146:147], v[156:157] op_sel_hi:[1,0]
    v_pk_mul_f32 v[148:149], v[148:149], v[156:157] op_sel_hi:[1,0]
    v_pk_mul_f32 v[150:151], v[150:151], v[156:157] op_sel_hi:[1,0]
    v_pk_mul_f32 v[152:153], v[152:153], v[156:157] op_sel_hi:[1,0]
    v_pk_mul_f32 v[154:155], v[154:155], v[156:157] op_sel_hi:[1,0]
    v_cvt_pk_bf16_f32 v144, v144, v145
    v_cvt_pk_bf16_f32 v145, v146, v147
    v_mfma_f32_32x32x16_bf16 v[176:191], v[108:111], v[52:55], v[176:191]
    v_cvt_pk_bf16_f32 v146, v148, v149
    v_cvt_pk_bf16_f32 v147, v150, v151
    v_cvt_pk_bf16_f32 v114, v152, v153
    v_cvt_pk_bf16_f32 v115, v154, v155
    buffer_store_dwordx4 v[144:147], v15, s[16:19], s56 offen offset:768 sc1
    s_mov_b32 exec_hi, 0
    buffer_store_dwordx4 v[112:115], v15, s[16:19], s56 offen offset:512 sc1
    s_mov_b32 exec_hi, -1
    s_nop 3
    v_add_f32 v172, 0x358637bd, v172
    v_rcp_f32 v172, v172
    s_nop 0
    v_pk_mul_f32 v[160:161], v[160:161], v[172:173] op_sel_hi:[1,0]
    v_pk_mul_f32 v[162:163], v[162:163], v[172:173] op_sel_hi:[1,0]
    v_pk_mul_f32 v[164:165], v[164:165], v[172:173] op_sel_hi:[1,0]
    v_pk_mul_f32 v[166:167], v[166:167], v[172:173] op_sel_hi:[1,0]
    v_pk_mul_f32 v[168:169], v[168:169], v[172:173] op_sel_hi:[1,0]
    v_pk_mul_f32 v[170:171], v[170:171], v[172:173] op_sel_hi:[1,0]
    v_cvt_pk_bf16_f32 v160, v160, v161
    v_cvt_pk_bf16_f32 v161, v162, v163
    v_cvt_pk_bf16_f32 v162, v164, v165
    v_cvt_pk_bf16_f32 v163, v166, v167
    v_cvt_pk_bf16_f32 v116, v168, v169
    v_cvt_pk_bf16_f32 v117, v170, v171
    buffer_store_dwordx4 v[160:163], v15, s[16:19], s56 offen offset:1280 sc1
    v_add_f32 v188, 0x358637bd, v188
    v_rcp_f32 v188, v188
    s_nop 0
    v_pk_mul_f32 v[176:177], v[176:177], v[188:189] op_sel_hi:[1,0]
    v_pk_mul_f32 v[178:179], v[178:179], v[188:189] op_sel_hi:[1,0]
    v_pk_mul_f32 v[180:181], v[180:181], v[188:189] op_sel_hi:[1,0]
    v_pk_mul_f32 v[182:183], v[182:183], v[188:189] op_sel_hi:[1,0]
    v_pk_mul_f32 v[184:185], v[184:185], v[188:189] op_sel_hi:[1,0]
    v_pk_mul_f32 v[186:187], v[186:187], v[188:189] op_sel_hi:[1,0]
    v_cvt_pk_bf16_f32 v176, v176, v177
    v_cvt_pk_bf16_f32 v177, v178, v179
    v_cvt_pk_bf16_f32 v178, v180, v181
    v_cvt_pk_bf16_f32 v179, v182, v183
    v_cvt_pk_bf16_f32 v118, v184, v185
    v_cvt_pk_bf16_f32 v119, v186, v187
    buffer_store_dwordx4 v[176:179], v15, s[16:19], s56 offen offset:2048 sc1
    s_mov_b32 exec_hi, 0
    buffer_store_dwordx4 v[116:119], v15, s[16:19], s56 offen offset:1792 sc1
    s_waitcnt vmcnt(0)
    s_mov_b64 exec, -1
    s_branch F_fin
F_or0:
    buffer_load_dwordx4 v[140:143], v4, s[16:19], s36 offen offset:0 sc1
    buffer_load_dwordx4 v[144:147], v4, s[16:19], s36 offen offset:256 sc1
    buffer_load_dwordx4 v[148:151], v4, s[16:19], s36 offen offset:512 sc1
    buffer_load_dwordx4 v[152:155], v4, s[16:19], s36 offen offset:768 sc1
    buffer_load_dwordx4 v[156:159], v4, s[16:19], s36 offen offset:1024 sc1
    buffer_load_dwordx4 v[160:163], v4, s[16:19], s36 offen offset:1280 sc1
    buffer_load_dwordx4 v[164:167], v4, s[16:19], s36 offen offset:1536 sc1
    buffer_load_dwordx4 v[168:171], v4, s[16:19], s37 offen offset:0 sc1
    buffer_load_dwordx4 v[172:175], v4, s[16:19], s37 offen offset:256 sc1
    buffer_load_dwordx4 v[176:179], v4, s[16:19], s37 offen offset:512 sc1
    buffer_load_dwordx4 v[180:183], v4, s[16:19], s37 offen offset:768 sc1
    buffer_load_dwordx4 v[184:187], v4, s[16:19], s37 offen offset:1024 sc1
    buffer_load_dwordx4 v[188:191], v4, s[16:19], s37 offen offset:1280 sc1
    buffer_load_dwordx4 v[192:195], v4, s[16:19], s37 offen offset:1536 sc1
    s_waitcnt vmcnt(0)
    s_branch F_ov0
F_or1:
    buffer_load_dwordx4 v[196:199], v4, s[16:19], s35 offen offset:0 sc1
    buffer_load_dwordx4 v[200:203], v4, s[16:19], s35 offen offset:256 sc1
    buffer_load_dwordx4 v[204:207], v4, s[16:19], s35 offen offset:512 sc1
    buffer_load_dwordx4 v[208:211], v4, s[16:19], s35 offen offset:768 sc1
    buffer_load_dwordx4 v[212:215], v4, s[16:19], s35 offen offset:1024 sc1
    buffer_load_dwordx4 v[216:219], v4, s[16:19], s35 offen offset:1280 sc1
    buffer_load_dwordx4 v[220:223], v4, s[16:19], s35 offen offset:1536 sc1
    buffer_load_dwordx4 v[224:227], v4, s[16:19], s44 offen offset:0 sc1
    buffer_load_dwordx4 v[228:231], v4, s[16:19], s44 offen offset:256 sc1
    buffer_load_dwordx4 v[232:235], v4, s[16:19], s44 offen offset:512 sc1
    buffer_load_dwordx4 v[236:239], v4, s[16:19], s44 offen offset:768 sc1
    buffer_load_dwordx4 v[240:243], v4, s[16:19], s44 offen offset:1024 sc1
    buffer_load_dwordx4 v[244:247], v4, s[16:19], s44 offen offset:1280 sc1
    buffer_load_dwordx4 v[248:251], v4, s[16:19], s44 offen offset:1536 sc1
    s_waitcnt vmcnt(0)
    s_branch F_ov1
F_c1_it2:
    s_cmp_eq_u32 s40, 8
    s_cbranch_scc1 F_c1_it0
    s_cmp_eq_u32 s40, 4
    s_cbranch_scc1 F_c1_itc
    s_cmp_eq_u32 s40, 1
    s_cbranch_scc1 F_c1_it1
    v_mov_b32 v13, 162592
    ds_read_b32 v12, v13
    s_waitcnt vmcnt(0) lgkmcnt(0)
    s_barrier
    v_readfirstlane_b32 s53, v12
    s_cmp_eq_u32 s31, 0
    s_cbranch_scc0 F_c1_it2r
    v_mov_b32 v13, 0
    s_mov_b64 exec, 1
    buffer_store_dword v12, v13, s[16:19], s54 offen sc1
    s_mov_b64 exec, -1
    s_branch F_c1_it2r
F_c1_it0:
    s_waitcnt vmcnt(0)
F_c1_itx:
    s_waitcnt lgkmcnt(0)
    s_barrier
    s_branch F_c1_it2r
F_c1_it1:
    s_branch F_c1_itx
F_c1_itc:
    s_getpc_b64 s[46:47]
F_c1_pc:
    s_sub_u32 s46, s46, F_c1_pc-parallel_sum__linear_kernel_hedgehog__dense_activation_squared_relu__prompt_kernel
    s_subb_u32 s47, s47, 0
    s_lshr_b32 s44, s2, 3
    s_lshl_b32 s44, s44, 2
    s_add_u32 s44, s44, s31
    s_lshl_b32 s44, s44, 9
    v_and_b32 v13, 3, v60
    v_lshl_add_u32 v13, v13, 7, s44
    v_min_u32 v13, F_end-parallel_sum__linear_kernel_hedgehog__dense_activation_squared_relu__prompt_kernel, v13
    global_load_dword v79, v13, s[46:47]
    s_branch F_c1_itx
F_fin:
    v_mov_b32 v1, 1
    v_mov_b32 v2, 162580
    s_mov_b64 exec, 1
    ds_add_rtn_u32 v3, v2, v1
    s_waitcnt lgkmcnt(0)
    s_mov_b64 exec, -1
    v_readfirstlane_b32 s47, v3
    s_cmp_eq_u32 s47, 3
    s_cbranch_scc0 F_ot_end
    s_cmp_eq_u32 s30, 1
    s_cbranch_scc0 F_ot_end
    v_mov_b32 v1, s53
    v_mov_b32 v2, 0
    s_mov_b64 exec, 1
    buffer_store_dword v1, v2, s[16:19], s51 offen sc1
    s_mov_b64 exec, -1
F_ot_end:
    s_endpgm
P0_fin:
    s_cmp_ge_u32 s31, 2
    s_cbranch_scc1 P0_fcols
    s_mov_b32 s37, 0xffff0000
    v_lshlrev_b32 v40, 16, v20
    v_and_b32 v41, s37, v20
    v_lshlrev_b32 v42, 16, v21
    v_and_b32 v43, s37, v21
    v_lshlrev_b32 v44, 16, v22
    v_and_b32 v45, s37, v22
    v_lshlrev_b32 v46, 16, v23
    v_and_b32 v47, s37, v23
    v_lshlrev_b32 v48, 16, v24
    v_and_b32 v49, s37, v24
    v_lshlrev_b32 v50, 16, v25
    v_and_b32 v51, s37, v25
    v_lshlrev_b32 v52, 16, v26
    v_and_b32 v53, s37, v26
    v_lshlrev_b32 v54, 16, v27
    v_and_b32 v55, s37, v27
    v_lshlrev_b32 v56, 16, v28
    v_and_b32 v57, s37, v28
    v_lshlrev_b32 v58, 16, v29
    v_and_b32 v59, s37, v29
    v_lshlrev_b32 v20, 16, v30
    v_and_b32 v21, s37, v30
    v_lshlrev_b32 v22, 16, v31
    v_and_b32 v23, s37, v31
    v_lshlrev_b32 v24, 16, v32
    v_and_b32 v25, s37, v32
    v_lshlrev_b32 v26, 16, v33
    v_and_b32 v27, s37, v33
    v_lshlrev_b32 v28, 16, v34
    v_and_b32 v29, s37, v34
    v_lshlrev_b32 v72, 16, v35
    v_and_b32 v73, s37, v35
    v_lshlrev_b32 v74, 16, v36
    v_and_b32 v75, s37, v36
    v_lshlrev_b32 v76, 16, v37
    v_and_b32 v77, s37, v37
    v_lshlrev_b32 v78, 16, v38
    v_and_b32 v79, s37, v38
    v_lshlrev_b32 v30, 16, v39
    v_and_b32 v31, s37, v39
    v_pk_add_f32 v[68:69], v[40:41], v[42:43]
    v_pk_add_f32 v[70:71], v[44:45], v[46:47]
    v_pk_add_f32 v[68:69], v[68:69], v[48:49]
    v_pk_add_f32 v[70:71], v[70:71], v[50:51]
    v_pk_add_f32 v[68:69], v[68:69], v[52:53]
    v_pk_add_f32 v[70:71], v[70:71], v[54:55]
    v_pk_add_f32 v[68:69], v[68:69], v[56:57]
    v_pk_add_f32 v[70:71], v[70:71], v[58:59]
    v_pk_add_f32 v[68:69], v[68:69], v[20:21]
    v_pk_add_f32 v[70:71], v[70:71], v[22:23]
    v_pk_add_f32 v[68:69], v[68:69], v[24:25]
    v_pk_add_f32 v[70:71], v[70:71], v[26:27]
    v_pk_add_f32 v[68:69], v[68:69], v[28:29]
    v_pk_add_f32 v[70:71], v[70:71], v[30:31]
    v_pk_add_f32 v[68:69], v[68:69], v[72:73]
    v_pk_add_f32 v[70:71], v[70:71], v[74:75]
    v_pk_add_f32 v[68:69], v[68:69], v[76:77]
    v_pk_add_f32 v[70:71], v[70:71], v[78:79]
    v_pk_add_f32 v[68:69], v[68:69], v[70:71]
    v_add_f32 v68, v68, v69
    s_nop 1
    v_add_f32_dpp v68, v68, v68 row_ror:8 row_mask:0xf bank_mask:0xf
    s_nop 1
    v_add_f32_dpp v68, v68, v68 row_ror:4 row_mask:0xf bank_mask:0xf
    s_nop 1
    v_add_f32_dpp v68, v68, v68 row_ror:2 row_mask:0xf bank_mask:0xf
    s_nop 1
    v_add_f32_dpp v68, v68, v68 row_ror:1 row_mask:0xf bank_mask:0xf
    v_mul_f32 v68, 0x3acccccd, v68
    v_pk_add_f32 v[40:41], v[40:41], v[68:69] op_sel_hi:[1,0] neg_lo:[0,1] neg_hi:[0,1]
    v_pk_add_f32 v[42:43], v[42:43], v[68:69] op_sel_hi:[1,0] neg_lo:[0,1] neg_hi:[0,1]
    v_pk_add_f32 v[44:45], v[44:45], v[68:69] op_sel_hi:[1,0] neg_lo:[0,1] neg_hi:[0,1]
    v_pk_add_f32 v[46:47], v[46:47], v[68:69] op_sel_hi:[1,0] neg_lo:[0,1] neg_hi:[0,1]
    v_pk_add_f32 v[48:49], v[48:49], v[68:69] op_sel_hi:[1,0] neg_lo:[0,1] neg_hi:[0,1]
    v_pk_add_f32 v[50:51], v[50:51], v[68:69] op_sel_hi:[1,0] neg_lo:[0,1] neg_hi:[0,1]
    v_pk_add_f32 v[52:53], v[52:53], v[68:69] op_sel_hi:[1,0] neg_lo:[0,1] neg_hi:[0,1]
    v_pk_add_f32 v[54:55], v[54:55], v[68:69] op_sel_hi:[1,0] neg_lo:[0,1] neg_hi:[0,1]
    v_pk_add_f32 v[56:57], v[56:57], v[68:69] op_sel_hi:[1,0] neg_lo:[0,1] neg_hi:[0,1]
    v_pk_add_f32 v[58:59], v[58:59], v[68:69] op_sel_hi:[1,0] neg_lo:[0,1] neg_hi:[0,1]
    v_pk_add_f32 v[20:21], v[20:21], v[68:69] op_sel_hi:[1,0] neg_lo:[0,1] neg_hi:[0,1]
    v_pk_add_f32 v[22:23], v[22:23], v[68:69] op_sel_hi:[1,0] neg_lo:[0,1] neg_hi:[0,1]
    v_pk_add_f32 v[24:25], v[24:25], v[68:69] op_sel_hi:[1,0] neg_lo:[0,1] neg_hi:[0,1]
    v_pk_add_f32 v[26:27], v[26:27], v[68:69] op_sel_hi:[1,0] neg_lo:[0,1] neg_hi:[0,1]
    v_pk_add_f32 v[28:29], v[28:29], v[68:69] op_sel_hi:[1,0] neg_lo:[0,1] neg_hi:[0,1]
    v_pk_add_f32 v[30:31], v[30:31], v[68:69] op_sel_hi:[1,0] neg_lo:[0,1] neg_hi:[0,1]
    v_pk_add_f32 v[72:73], v[72:73], v[68:69] op_sel_hi:[1,0] neg_lo:[0,1] neg_hi:[0,1]
    v_pk_add_f32 v[74:75], v[74:75], v[68:69] op_sel_hi:[1,0] neg_lo:[0,1] neg_hi:[0,1]
    v_pk_add_f32 v[76:77], v[76:77], v[68:69] op_sel_hi:[1,0] neg_lo:[0,1] neg_hi:[0,1]
    v_pk_add_f32 v[78:79], v[78:79], v[68:69] op_sel_hi:[1,0] neg_lo:[0,1] neg_hi:[0,1]
    v_pk_mul_f32 v[70:71], v[40:41], v[40:41]
    v_pk_mul_f32 v[32:33], v[42:43], v[42:43]
    v_pk_fma_f32 v[70:71], v[44:45], v[44:45], v[70:71]
    v_pk_fma_f32 v[32:33], v[46:47], v[46:47], v[32:33]
    v_pk_fma_f32 v[70:71], v[48:49], v[48:49], v[70:71]
    v_pk_fma_f32 v[32:33], v[50:51], v[50:51], v[32:33]
    v_pk_fma_f32 v[70:71], v[52:53], v[52:53], v[70:71]
    v_pk_fma_f32 v[32:33], v[54:55], v[54:55], v[32:33]
    v_pk_fma_f32 v[70:71], v[56:57], v[56:57], v[70:71]
    v_pk_fma_f32 v[32:33], v[58:59], v[58:59], v[32:33]
    v_pk_fma_f32 v[70:71], v[20:21], v[20:21], v[70:71]
    v_pk_fma_f32 v[32:33], v[22:23], v[22:23], v[32:33]
    v_pk_fma_f32 v[70:71], v[24:25], v[24:25], v[70:71]
    v_pk_fma_f32 v[32:33], v[26:27], v[26:27], v[32:33]
    v_pk_fma_f32 v[70:71], v[28:29], v[28:29], v[70:71]
    v_pk_fma_f32 v[32:33], v[30:31], v[30:31], v[32:33]
    v_pk_fma_f32 v[70:71], v[72:73], v[72:73], v[70:71]
    v_pk_fma_f32 v[32:33], v[74:75], v[74:75], v[32:33]
    v_pk_fma_f32 v[70:71], v[76:77], v[76:77], v[70:71]
    v_pk_fma_f32 v[32:33], v[78:79], v[78:79], v[32:33]
    v_pk_add_f32 v[70:71], v[70:71], v[32:33]
    v_add_f32 v69, v70, v71
    s_nop 1
    v_add_f32_dpp v69, v69, v69 row_ror:8 row_mask:0xf bank_mask:0xf
    s_nop 1
    v_add_f32_dpp v69, v69, v69 row_ror:4 row_mask:0xf bank_mask:0xf
    s_nop 1
    v_add_f32_dpp v69, v69, v69 row_ror:2 row_mask:0xf bank_mask:0xf
    s_nop 1
    v_add_f32_dpp v69, v69, v69 row_ror:1 row_mask:0xf bank_mask:0xf
    v_mov_b32 v70, 0x3727c5ac
    v_fmac_f32 v70, 0x3acccccd, v69
    v_rsq_f32 v69, v70
    v_lshlrev_b32 v65, 3, v65
    v_cmp_eq_u32 vcc, 0, v66
    s_and_saveexec_b64 s[48:49], vcc
    s_nop 1
    buffer_store_dwordx2 v[68:69], v65, s[16:19], 0 offen sc1
    s_mov_b64 exec, -1
    s_branch P0_done
P0_fcols:
    s_cmp_ge_u32 s2, 216
    s_cbranch_scc1 P0_done
    v_and_b32 v68, 15, v60
    v_and_b32 v69, 1, v60
    v_lshlrev_b32 v69, 4, v69
    v_mov_b32 v70, 0x3f80
    v_lshlrev_b32 v69, v69, v70
    v_lshrrev_b32 v68, 1, v68
    v_cmp_eq_u32 vcc, 0, v68
    s_nop 1
    v_cndmask_b32 v64, 0, v69, vcc
    v_cmp_eq_u32 vcc, 1, v68
    s_nop 1
    v_cndmask_b32 v65, 0, v69, vcc
    v_cmp_eq_u32 vcc, 2, v68
    s_nop 1
    v_cndmask_b32 v66, 0, v69, vcc
    v_cmp_eq_u32 vcc, 3, v68
    s_nop 1
    v_cndmask_b32 v67, 0, v69, vcc
    s_nop 1
    v_mfma_f32_16x16x32_bf16 v[68:71], v[64:67], v[20:23], 0
    v_mfma_f32_16x16x32_bf16 v[68:71], v[64:67], v[24:27], v[68:71]
    v_mfma_f32_16x16x32_bf16 v[68:71], v[64:67], v[28:31], v[68:71]
    v_mfma_f32_16x16x32_bf16 v[68:71], v[64:67], v[32:35], v[68:71]
    v_mfma_f32_16x16x32_bf16 v[68:71], v[64:67], v[36:39], v[68:71]
    v_mfma_f32_16x16x32_bf16 v[68:71], v[64:67], v[40:43], v[68:71]
    v_mfma_f32_16x16x32_bf16 v[68:71], v[64:67], v[44:47], v[68:71]
    v_mfma_f32_16x16x32_bf16 v[68:71], v[64:67], v[48:51], v[68:71]
    v_mfma_f32_16x16x32_bf16 v[68:71], v[64:67], v[52:55], v[68:71]
    v_mfma_f32_16x16x32_bf16 v[68:71], v[64:67], v[56:59], v[68:71]
    s_mul_i32 s36, s34, 13824
    s_lshl_b32 s35, s33, 8
    s_add_u32 s36, s36, s35
    s_add_u32 s36, s36, 32768
    v_and_b32 v76, 7, v60
    v_lshlrev_b32 v76, 5, v76
    v_and_b32 v77, 16, v60
    v_add_u32 v76, v76, v77
    v_and_b32 v77, 40, v60
    s_nop 1
    v_add_f32_dpp v72, v68, v68 row_ror:8 row_mask:0xf bank_mask:0xf
    s_nop 1
    v_add_f32_dpp v73, v69, v69 row_ror:8 row_mask:0xf bank_mask:0xf
    s_nop 1
    v_add_f32_dpp v74, v70, v70 row_ror:8 row_mask:0xf bank_mask:0xf
    s_nop 1
    v_add_f32_dpp v75, v71, v71 row_ror:8 row_mask:0xf bank_mask:0xf
    v_cmp_eq_u32 vcc, 0, v77
    s_and_saveexec_b64 s[48:49], vcc
    s_nop 1
    buffer_store_dwordx4 v[72:75], v76, s[16:19], s36 offen sc1
    s_mov_b64 exec, -1
P0_done:
    s_setpc_b64 s[58:59]
F_end:
    s_endpgm
.section .rodata,"a"
.p2align 6
.amdhsa_kernel parallel_sum__linear_kernel_hedgehog__dense_activation_squared_relu__prompt_kernel
  .amdhsa_next_free_vgpr 256
  .amdhsa_next_free_sgpr 102
  .amdhsa_accum_offset 256
  .amdhsa_group_segment_fixed_size 0
  .amdhsa_kernarg_size 96
  .amdhsa_user_sgpr_count 2
  .amdhsa_user_sgpr_kernarg_segment_ptr 1
  .amdhsa_system_sgpr_workgroup_id_x 1
  .amdhsa_float_denorm_mode_32 3
  .amdhsa_float_denorm_mode_16_64 3
.end_amdhsa_kernel
```
